```python
import torch

def _softmax(x, axis=-1):
    return torch.softmax(x, dim=axis)
def _gelu(x):
    return torch.nn.functional.gelu(x, approximate="tanh")
def _silu(x):
    return torch.nn.functional.silu(x)
def _sigmoid(x):
    return torch.sigmoid(x)
def _layernorm(x, axis=-1, eps=1e-5):
    m = x.mean(dim=axis, keepdim=True)
    v = x.var(dim=axis, keepdim=True, unbiased=False)
    return (x - m) / torch.sqrt(v + eps)
def _scatter_add(tgt, idx, src, axis=0):
    return tgt.clone().index_add_(axis, idx, src)
def _segment_sum(src, seg, n):
    out = torch.zeros((n,) + src.shape[1:], dtype=src.dtype)
    return out.index_add_(0, seg, src)
def _pad(x, pw):
    flat = tuple(v for pair in reversed(pw) for v in pair)
    return torch.nn.functional.pad(x, flat)

kernel_name = 'standalone__gqa_block_cached__near_ridge'

def setup_inputs():

    _w = (lambda a: (lambda t: t.to(torch.bfloat16) if t.is_floating_point() else t)(torch.as_tensor(a)))
    B, Sq, D = 8, 96, 640
    Hq, Hkv, Sk, Dh = 32, 32, 96, 192
    assert Hq % Hkv == 0, (Hq, Hkv)
    return {
        "x": _w((lambda *s: torch.randn(*s, dtype=torch.bfloat16) * 0.8)(B, Sq, D)),
        "k_cache": _w((lambda *s: torch.randn(*s, dtype=torch.bfloat16) * 0.8)(B, Hkv, Sk, Dh)),
        "v_cache": _w((lambda *s: torch.randn(*s, dtype=torch.bfloat16) * 0.05)(B, Hkv, Sk, Dh)),
        "wq": _w((lambda *s: torch.randn(*s, dtype=torch.bfloat16) * 0.8)(D, Hq * Dh) * (D ** -0.5)),
        "wo": _w((lambda *s: torch.randn(*s, dtype=torch.bfloat16) * 0.05)(Hq * Dh, D) * ((Hq * Dh) ** -0.5)),
    }

def reference(x, k_cache, v_cache, wq, wo):
    B, Sq, D = x.shape
    Hq, Dh = 32, 192
    Hkv = k_cache.shape[1]
    rep = Hq // Hkv
    q = (lambda x, *d: x.permute(*d))((x @ wq).reshape(B, Sq, Hq, Dh), 0, 2, 1, 3)
    k = (lambda x, n, axis: torch.repeat_interleave(x, n, dim=axis))(k_cache, rep, axis=1)
    v = (lambda x, n, axis: torch.repeat_interleave(x, n, dim=axis))(v_cache, rep, axis=1)
    scores = torch.einsum("bhqd,bhkd->bhqk", q, k) * (Dh ** -0.5)
    p = _softmax(scores, axis=-1)
    o = torch.einsum("bhqk,bhkd->bhqd", p, v)
    return (lambda x, *d: x.permute(*d))(o, 0, 2, 1, 3).reshape(B, Sq, Hq * Dh) @ wo
```

```asm
; @launch grid=(256,1,1) block=(512,1,1) lds=163840
.amdgcn_target "amdgcn-amd-amdhsa--gfx950"
.text
.globl standalone__gqa_block_cached__near_ridge_kernel
.p2align 8
.type standalone__gqa_block_cached__near_ridge_kernel,@function
standalone__gqa_block_cached__near_ridge_kernel:
    s_cmp_ge_u32 s2, 256
    s_cbranch_scc1 L_end
    s_load_dwordx16 s[4:19], s[0:1], 0
    v_lshrrev_b32 v1, 6, v0
    v_lshlrev_b32 v2, 7, v0
    v_readfirstlane_b32 s20, v1
    s_nop 1
    s_cmp_ge_u32 s20, 4
    s_cbranch_scc1 L_nopf
    s_getpc_b64 s[58:59]
L_pc:
    s_sub_u32 s58, s58, L_pc-standalone__gqa_block_cached__near_ridge_kernel
    s_subb_u32 s59, s59, 0
    v_min_u32 v2, L_end-standalone__gqa_block_cached__near_ridge_kernel, v2
    global_load_dword v253, v2, s[58:59]
L_nopf:
    v_and_b32 v0, 63, v0
    s_and_b32 s21, s2, 7
    s_lshr_b32 s56, s2, 3
    s_lshr_b32 s22, s56, 2
    s_and_b32 s23, s56, 3
    s_lshl_b32 s24, s21, 2
    s_add_u32 s24, s24, s23
    s_lshl_b32 s25, s22, 5
    s_add_u32 s25, s25, s24
    s_lshl_b32 s76, s25, 11
    s_add_u32 s76, s76, 264241152
    s_cmp_lt_u32 s20, 4
    s_cbranch_scc1 L_computeA
    s_mov_b32 s66, 1
    s_sub_u32 s60, s20, 4
    s_mul_i32 s56, s60, 98304
    s_mul_i32 s57, s24, 384
    s_add_u32 s56, s56, s57
    s_and_b32 s57, s60, 1
    s_lshl_b32 s57, s57, 2
    v_add_u32 v2, 0, v0
    v_mul_u32_u24 v3, 2731, v2
    v_lshrrev_b32 v235, 16, v3
    v_mul_u32_u24 v4, 24, v235
    v_sub_u32 v238, v2, v4
    v_and_b32 v5, 2, v235
    v_or_b32 v5, s57, v5
    v_xor_b32 v5, v5, v238
    v_mul_u32_u24 v6, 12288, v235
    v_lshl_add_u32 v6, v5, 4, v6
    v_add_u32 v220, s56, v6
    v_add_u32 v2, 64, v0
    v_mul_u32_u24 v3, 2731, v2
    v_lshrrev_b32 v236, 16, v3
    v_mul_u32_u24 v4, 24, v236
    v_sub_u32 v239, v2, v4
    v_and_b32 v5, 2, v236
    v_or_b32 v5, s57, v5
    v_xor_b32 v5, v5, v239
    v_mul_u32_u24 v6, 12288, v236
    v_lshl_add_u32 v6, v5, 4, v6
    v_add_u32 v221, s56, v6
    v_add_u32 v2, 128, v0
    v_mul_u32_u24 v3, 2731, v2
    v_lshrrev_b32 v237, 16, v3
    v_mul_u32_u24 v4, 24, v237
    v_sub_u32 v240, v2, v4
    v_and_b32 v5, 2, v237
    v_or_b32 v5, s57, v5
    v_xor_b32 v5, v5, v240
    v_mul_u32_u24 v6, 12288, v237
    v_lshl_add_u32 v6, v5, 4, v6
    v_add_u32 v222, s56, v6
    s_mul_i32 s58, s22, 96
    s_mul_i32 s59, s60, 24
    s_add_u32 s58, s58, s59
    s_mul_i32 s58, s58, 1280
    v_lshrrev_b32 v2, 3, v0
    v_mul_u32_u24 v2, 1280, v2
    v_and_b32 v3, 7, v0
    v_lshrrev_b32 v4, 4, v0
    v_xor_b32 v3, v3, v4
    v_xor_b32 v3, s57, v3
    v_lshl_add_u32 v223, v3, 4, v2
    v_add_u32 v223, s58, v223
    v_xor_b32 v3, 4, v3
    v_lshl_add_u32 v224, v3, 4, v2
    s_add_u32 s59, s58, 10240
    v_add_u32 v224, s59, v224
    v_add_u32 v225, 20480, v223
    s_mul_i32 s61, s60, 3072
    s_mul_i32 s58, s22, 10
    s_mul_i32 s59, s23, 10
    s_add_u32 s58, s58, s59
    s_add_u32 s58, s58, 2
    s_lshr_b32 s58, s58, 2
    s_cmp_ge_u32 s58, 20
    s_cselect_b32 s59, 20, 0
    s_sub_u32 s58, s58, s59
    s_cmp_ge_u32 s58, 10
    s_cselect_b32 s59, 10, 0
    s_sub_u32 s58, s58, s59
    s_mul_i32 s92, s58, 786432
    s_lshl_b32 s93, s58, 7
    s_waitcnt lgkmcnt(0)
    s_mov_b32 s32, s10
    s_and_b32 s33, s11, 0xffff
    s_mov_b32 s34, 7864320
    s_mov_b32 s35, 0x20000
    s_mov_b32 s28, s4
    s_and_b32 s29, s5, 0xffff
    s_mov_b32 s30, 983040
    s_mov_b32 s31, 0x20000
    s_add_u32 m0, s61, 0
    s_nop 0
    buffer_load_dwordx4 v220, s[32:35], s92 offen  lds
    s_add_u32 m0, s61, 1024
    s_nop 0
    buffer_load_dwordx4 v221, s[32:35], s92 offen  lds
    s_add_u32 m0, s61, 2048
    s_nop 0
    buffer_load_dwordx4 v222, s[32:35], s92 offen  lds
    s_add_u32 s92, s92, 393216
    s_cmp_eq_u32 s92, 7864320
    s_cselect_b32 s92, 0, s92
    s_add_u32 m0, s61, 49152
    s_nop 0
    buffer_load_dwordx4 v223, s[28:31], s93 offen  lds
    s_add_u32 m0, s61, 50176
    s_nop 0
    buffer_load_dwordx4 v224, s[28:31], s93 offen  lds
    s_add_u32 m0, s61, 51200
    s_nop 0
    buffer_load_dwordx4 v225, s[28:31], s93 offen  lds
    s_add_u32 s93, s93, 128
    s_cmp_eq_u32 s93, 1280
    s_cselect_b32 s93, 0, s93
    s_mov_b32 s44, s18
    s_and_b32 s45, s19, 0xffff
    s_mov_b32 s46, 268435456
    s_mov_b32 s47, 0x20000
    s_mov_b32 s68, s16
    s_and_b32 s69, s17, 0xffff
    s_mov_b32 s70, 256
    s_mov_b32 s71, 0x20000
    s_add_u32 m0, s61, 12288
    s_nop 0
    buffer_load_dwordx4 v220, s[32:35], s92 offen  lds
    s_add_u32 m0, s61, 13312
    s_nop 0
    buffer_load_dwordx4 v221, s[32:35], s92 offen  lds
    s_add_u32 m0, s61, 14336
    s_nop 0
    buffer_load_dwordx4 v222, s[32:35], s92 offen  lds
    s_add_u32 s92, s92, 393216
    s_cmp_eq_u32 s92, 7864320
    s_cselect_b32 s92, 0, s92
    s_mov_b32 s36, s6
    s_and_b32 s37, s7, 0xffff
    s_mov_b32 s38, 9437184
    s_mov_b32 s39, 0x20000
    s_mov_b32 s40, s8
    s_and_b32 s41, s9, 0xffff
    s_mov_b32 s42, 9437184
    s_mov_b32 s43, 0x20000
    s_mov_b32 s48, s12
    s_and_b32 s49, s13, 0xffff
    s_mov_b32 s50, 7864320
    s_mov_b32 s51, 0x20000
    s_mov_b32 s52, s14
    s_and_b32 s53, s15, 0xffff
    s_mov_b32 s54, 983040
    s_mov_b32 s55, 0x20000
    s_mul_i32 s63, s60, 9216
    s_mul_i32 s58, s25, 36864
    s_add_u32 s58, s58, s63
    v_mul_u32_u24 v6, 384, v235
    v_add_u32 v6, s58, v6
    v_lshrrev_b32 v3, 1, v235
    v_xor_b32 v4, v3, v238
    v_xor_b32 v4, s57, v4
    v_lshl_add_u32 v226, v4, 4, v6
    v_xor_b32 v4, 4, v4
    v_lshl_add_u32 v229, v4, 4, v6
    v_and_b32 v3, 1, v3
    v_lshlrev_b32 v3, 2, v3
    v_xor_b32 v4, v3, v238
    v_lshl_add_u32 v232, v4, 4, v6
    v_mul_u32_u24 v6, 384, v236
    v_add_u32 v6, s58, v6
    v_lshrrev_b32 v3, 1, v236
    v_xor_b32 v4, v3, v239
    v_xor_b32 v4, s57, v4
    v_lshl_add_u32 v227, v4, 4, v6
    v_xor_b32 v4, 4, v4
    v_lshl_add_u32 v230, v4, 4, v6
    v_and_b32 v3, 1, v3
    v_lshlrev_b32 v3, 2, v3
    v_xor_b32 v4, v3, v239
    v_lshl_add_u32 v233, v4, 4, v6
    v_mul_u32_u24 v6, 384, v237
    v_add_u32 v6, s58, v6
    v_lshrrev_b32 v3, 1, v237
    v_xor_b32 v4, v3, v240
    v_xor_b32 v4, s57, v4
    v_lshl_add_u32 v228, v4, 4, v6
    v_xor_b32 v4, 4, v4
    v_lshl_add_u32 v231, v4, 4, v6
    v_and_b32 v3, 1, v3
    v_lshlrev_b32 v3, 2, v3
    v_xor_b32 v4, v3, v240
    v_lshl_add_u32 v234, v4, 4, v6
    s_add_u32 m0, s61, 24576
    s_nop 0
    buffer_load_dwordx4 v220, s[32:35], s92 offen  lds
    s_add_u32 m0, s61, 25600
    s_nop 0
    buffer_load_dwordx4 v221, s[32:35], s92 offen  lds
    s_add_u32 m0, s61, 26624
    s_nop 0
    buffer_load_dwordx4 v222, s[32:35], s92 offen  lds
    s_add_u32 s92, s92, 393216
    s_cmp_eq_u32 s92, 7864320
    s_cselect_b32 s92, 0, s92
    s_add_u32 m0, s61, 61440
    s_nop 0
    buffer_load_dwordx4 v223, s[28:31], s93 offen  lds
    s_add_u32 m0, s61, 62464
    s_nop 0
    buffer_load_dwordx4 v224, s[28:31], s93 offen  lds
    s_add_u32 m0, s61, 63488
    s_nop 0
    buffer_load_dwordx4 v225, s[28:31], s93 offen  lds
    s_add_u32 s93, s93, 128
    s_cmp_eq_u32 s93, 1280
    s_cselect_b32 s93, 0, s93
    s_add_u32 m0, s61, 36864
    s_nop 0
    buffer_load_dwordx4 v220, s[32:35], s92 offen  lds
    s_add_u32 m0, s61, 37888
    s_nop 0
    buffer_load_dwordx4 v221, s[32:35], s92 offen  lds
    s_add_u32 m0, s61, 38912
    s_nop 0
    buffer_load_dwordx4 v222, s[32:35], s92 offen  lds
    s_add_u32 s92, s92, 393216
    s_cmp_eq_u32 s92, 7864320
    s_cselect_b32 s92, 0, s92
    s_add_u32 m0, s61, 73728
    s_nop 0
    buffer_load_dwordx4 v223, s[28:31], s93 offen  lds
    s_add_u32 m0, s61, 74752
    s_nop 0
    buffer_load_dwordx4 v224, s[28:31], s93 offen  lds
    s_add_u32 m0, s61, 75776
    s_nop 0
    buffer_load_dwordx4 v225, s[28:31], s93 offen  lds
    s_add_u32 s93, s93, 128
    s_cmp_eq_u32 s93, 1280
    s_cselect_b32 s93, 0, s93
    s_and_b32 s57, s60, 1
    s_lshr_b32 s58, s60, 1
    s_mul_i32 s77, s58, 40960
    s_mul_i32 s78, s60, 5120
    s_mul_i32 s57, s57, 320
    s_mul_i32 s58, s21, 983040
    s_mul_i32 s59, s23, 320
    s_add_u32 s58, s58, s59
    v_add_u32 v2, s57, v0
    v_add_u32 v2, 0, v2
    v_mul_u32_u24 v3, 3277, v2
    v_lshrrev_b32 v3, 16, v3
    v_mul_u32_u24 v4, 20, v3
    v_sub_u32 v4, v2, v4
    v_lshrrev_b32 v5, 1, v3
    v_and_b32 v5, 2, v5
    v_xor_b32 v4, v4, v5
    v_mul_u32_u24 v3, 1280, v3
    v_lshl_add_u32 v3, v4, 4, v3
    v_add_u32 v241, s58, v3
    v_add_u32 v2, s57, v0
    v_add_u32 v2, 64, v2
    v_mul_u32_u24 v3, 3277, v2
    v_lshrrev_b32 v3, 16, v3
    v_mul_u32_u24 v4, 20, v3
    v_sub_u32 v4, v2, v4
    v_lshrrev_b32 v5, 1, v3
    v_and_b32 v5, 2, v5
    v_xor_b32 v4, v4, v5
    v_mul_u32_u24 v3, 1280, v3
    v_lshl_add_u32 v3, v4, 4, v3
    v_add_u32 v242, s58, v3
    v_add_u32 v2, s57, v0
    v_add_u32 v2, 128, v2
    v_mul_u32_u24 v3, 3277, v2
    v_lshrrev_b32 v3, 16, v3
    v_mul_u32_u24 v4, 20, v3
    v_sub_u32 v4, v2, v4
    v_lshrrev_b32 v5, 1, v3
    v_and_b32 v5, 2, v5
    v_xor_b32 v4, v4, v5
    v_mul_u32_u24 v3, 1280, v3
    v_lshl_add_u32 v3, v4, 4, v3
    v_add_u32 v243, s58, v3
    v_add_u32 v2, s57, v0
    v_add_u32 v2, 192, v2
    v_mul_u32_u24 v3, 3277, v2
    v_lshrrev_b32 v3, 16, v3
    v_mul_u32_u24 v4, 20, v3
    v_sub_u32 v4, v2, v4
    v_lshrrev_b32 v5, 1, v3
    v_and_b32 v5, 2, v5
    v_xor_b32 v4, v4, v5
    v_mul_u32_u24 v3, 1280, v3
    v_lshl_add_u32 v3, v4, 4, v3
    v_add_u32 v244, s58, v3
    v_add_u32 v2, s57, v0
    v_add_u32 v2, 256, v2
    v_mul_u32_u24 v3, 3277, v2
    v_lshrrev_b32 v3, 16, v3
    v_mul_u32_u24 v4, 20, v3
    v_sub_u32 v4, v2, v4
    v_lshrrev_b32 v5, 1, v3
    v_and_b32 v5, 2, v5
    v_xor_b32 v4, v4, v5
    v_mul_u32_u24 v3, 1280, v3
    v_lshl_add_u32 v3, v4, 4, v3
    v_add_u32 v245, s58, v3
    s_mul_i32 s73, s23, 245760
    s_mul_i32 s98, s23, 3
    s_add_u32 s98, s98, 4
    s_mov_b32 s94, s22
    s_mov_b32 s95, s22
    v_lshlrev_b32 v7, 4, v0
    s_add_u32 s57, s78, 36864
    v_add_u32 v218, s57, v7
    v_add_u32 v219, 40960, v218
    s_add_u32 s57, s23, 1
    s_and_b32 s57, s57, 3
    s_mul_i32 s75, s57, 36864
    s_mul_i32 s74, s60, 3072
    s_lshl_b32 s57, s22, 3
    s_add_u32 s57, s57, s21
    s_mul_i32 s57, s57, 147456
    s_add_u32 s57, s57, s74
    s_add_u32 s57, s57, 234881024
    v_add_u32 v246, s57, v7
    v_min_u32 v2, 11, v0
    v_lshlrev_b32 v2, 2, v2
    s_add_u32 s57, s76, 1024
    v_add_u32 v249, s57, v2
    v_min_u32 v2, 7, v0
    v_max_u32 v2, 1, v2
    v_add_u32 v2, s21, v2
    v_and_b32 v2, 7, v2
    v_lshlrev_b32 v3, 7, v2
    v_add_u32 v250, s76, v3
    s_lshr_b32 s57, s2, 3
    s_lshl_b32 s57, s57, 2
    s_add_u32 s57, s57, s60
    s_mul_i32 s57, s57, 7680
    s_mul_i32 s58, s21, 983040
    s_add_u32 s57, s57, s58
    v_min_u32 v2, 59, v0
    v_lshlrev_b32 v2, 7, v2
    v_add_u32 v251, s57, v2
    s_and_b32 s56, s21, 1
    s_lshl_b32 s56, s56, 2
    s_add_u32 s96, s56, s60
    s_lshl_b32 s58, s22, 2
    s_add_u32 s58, s58, s23
    s_lshl_b32 s58, s58, 5
    s_lshr_b32 s57, s21, 1
    s_add_u32 s58, s58, s57
    s_lshl_b32 s58, s58, 3
    s_add_u32 s58, s58, s96
    s_lshl_b32 s58, s58, 10
    s_add_u32 s58, s58, 251658240
    v_add_u32 v247, s58, v7
    s_bfe_u32 s56, s21, 0x10001
    s_lshr_b32 s57, s21, 2
    s_mul_i32 s57, s57, 48
    s_mul_i32 s58, s22, 96
    s_add_u32 s57, s57, s58
    s_lshr_b32 s58, s96, 1
    s_cmp_eq_u32 s96, 6
    s_cselect_b32 s58, 0, s58
    s_cmp_eq_u32 s96, 7
    s_cselect_b32 s58, 2, s58
    s_lshl_b32 s58, s58, 4
    s_add_u32 s57, s57, s58
    s_mul_i32 s57, s57, 1280
    s_and_b32 s58, s96, 1
    s_lshl_b32 s58, s58, 6
    s_mul_i32 s59, s56, 192
    s_add_u32 s58, s58, s59
    s_lshl_b32 s59, s56, 5
    s_add_u32 s59, s59, 128
    s_cmp_ge_u32 s96, 6
    s_cselect_b32 s58, s59, s58
    s_add_u32 s57, s57, s58
    s_mul_i32 s58, s23, 320
    s_add_u32 s57, s57, s58
    v_and_b32 v2, 15, v0
    v_mul_u32_u24 v2, 1280, v2
    v_lshrrev_b32 v3, 4, v0
    v_lshl_add_u32 v2, v3, 3, v2
    v_add_u32 v248, s57, v2
    s_mov_b32 s97, 32
    s_cmp_eq_u32 s96, 6
    s_cselect_b32 s97, 20480, s97
    s_cmp_eq_u32 s96, 7
    s_cselect_b32 s97, 16, s97
    s_waitcnt vmcnt(15)
    s_barrier
    s_lshr_b32 s57, s2, 3
    s_and_b32 s57, s57, 1
    s_cmp_eq_u32 s57, 1
    s_cbranch_scc1 L_kvvar1
    s_waitcnt vmcnt(12)
    s_barrier
    s_add_u32 m0, s61, 0
    s_nop 0
    buffer_load_dwordx4 v220, s[32:35], s92 offen  lds
    s_add_u32 m0, s61, 1024
    s_nop 0
    buffer_load_dwordx4 v221, s[32:35], s92 offen  lds
    s_add_u32 m0, s61, 2048
    s_nop 0
    buffer_load_dwordx4 v222, s[32:35], s92 offen  lds
    s_add_u32 s92, s92, 393216
    s_cmp_eq_u32 s92, 7864320
    s_cselect_b32 s92, 0, s92
    s_waitcnt vmcnt(9)
    s_barrier
    s_add_u32 m0, s61, 12288
    s_nop 0
    buffer_load_dwordx4 v220, s[32:35], s92 offen  lds
    s_add_u32 m0, s61, 13312
    s_nop 0
    buffer_load_dwordx4 v221, s[32:35], s92 offen  lds
    s_add_u32 m0, s61, 14336
    s_nop 0
    buffer_load_dwordx4 v222, s[32:35], s92 offen  lds
    s_add_u32 s92, s92, 393216
    s_cmp_eq_u32 s92, 7864320
    s_cselect_b32 s92, 0, s92
    s_add_u32 m0, s61, 49152
    s_nop 0
    buffer_load_dwordx4 v223, s[28:31], s93 offen  lds
    s_add_u32 m0, s61, 50176
    s_nop 0
    buffer_load_dwordx4 v224, s[28:31], s93 offen  lds
    s_add_u32 m0, s61, 51200
    s_nop 0
    buffer_load_dwordx4 v225, s[28:31], s93 offen  lds
    s_add_u32 s93, s93, 128
    s_cmp_eq_u32 s93, 1280
    s_cselect_b32 s93, 0, s93
    s_waitcnt vmcnt(12)
    s_barrier
    s_add_u32 m0, s61, 24576
    s_nop 0
    buffer_load_dwordx4 v220, s[32:35], s92 offen  lds
    s_add_u32 m0, s61, 25600
    s_nop 0
    buffer_load_dwordx4 v221, s[32:35], s92 offen  lds
    s_add_u32 m0, s61, 26624
    s_nop 0
    buffer_load_dwordx4 v222, s[32:35], s92 offen  lds
    s_add_u32 s92, s92, 393216
    s_cmp_eq_u32 s92, 7864320
    s_cselect_b32 s92, 0, s92
    s_waitcnt vmcnt(9)
    s_barrier
    s_add_u32 m0, s61, 36864
    s_nop 0
    buffer_load_dwordx4 v220, s[32:35], s92 offen  lds
    s_add_u32 m0, s61, 37888
    s_nop 0
    buffer_load_dwordx4 v221, s[32:35], s92 offen  lds
    s_add_u32 m0, s61, 38912
    s_nop 0
    buffer_load_dwordx4 v222, s[32:35], s92 offen  lds
    s_add_u32 s92, s92, 393216
    s_cmp_eq_u32 s92, 7864320
    s_cselect_b32 s92, 0, s92
    s_add_u32 m0, s61, 61440
    s_nop 0
    buffer_load_dwordx4 v223, s[28:31], s93 offen  lds
    s_add_u32 m0, s61, 62464
    s_nop 0
    buffer_load_dwordx4 v224, s[28:31], s93 offen  lds
    s_add_u32 m0, s61, 63488
    s_nop 0
    buffer_load_dwordx4 v225, s[28:31], s93 offen  lds
    s_add_u32 s93, s93, 128
    s_cmp_eq_u32 s93, 1280
    s_cselect_b32 s93, 0, s93
    s_waitcnt vmcnt(12)
    s_barrier
    s_add_u32 m0, s61, 0
    s_nop 0
    buffer_load_dwordx4 v220, s[32:35], s92 offen  lds
    s_add_u32 m0, s61, 1024
    s_nop 0
    buffer_load_dwordx4 v221, s[32:35], s92 offen  lds
    s_add_u32 m0, s61, 2048
    s_nop 0
    buffer_load_dwordx4 v222, s[32:35], s92 offen  lds
    s_add_u32 s92, s92, 393216
    s_cmp_eq_u32 s92, 7864320
    s_cselect_b32 s92, 0, s92
    s_waitcnt vmcnt(9)
    s_barrier
    s_add_u32 m0, s61, 12288
    s_nop 0
    buffer_load_dwordx4 v220, s[32:35], s92 offen  lds
    s_add_u32 m0, s61, 13312
    s_nop 0
    buffer_load_dwordx4 v221, s[32:35], s92 offen  lds
    s_add_u32 m0, s61, 14336
    s_nop 0
    buffer_load_dwordx4 v222, s[32:35], s92 offen  lds
    s_add_u32 s92, s92, 393216
    s_cmp_eq_u32 s92, 7864320
    s_cselect_b32 s92, 0, s92
    s_add_u32 m0, s61, 73728
    s_nop 0
    buffer_load_dwordx4 v223, s[28:31], s93 offen  lds
    s_add_u32 m0, s61, 74752
    s_nop 0
    buffer_load_dwordx4 v224, s[28:31], s93 offen  lds
    s_add_u32 m0, s61, 75776
    s_nop 0
    buffer_load_dwordx4 v225, s[28:31], s93 offen  lds
    s_add_u32 s93, s93, 128
    s_cmp_eq_u32 s93, 1280
    s_cselect_b32 s93, 0, s93
    s_waitcnt vmcnt(12)
    s_barrier
    s_add_u32 m0, s61, 24576
    s_nop 0
    buffer_load_dwordx4 v220, s[32:35], s92 offen  lds
    s_add_u32 m0, s61, 25600
    s_nop 0
    buffer_load_dwordx4 v221, s[32:35], s92 offen  lds
    s_add_u32 m0, s61, 26624
    s_nop 0
    buffer_load_dwordx4 v222, s[32:35], s92 offen  lds
    s_add_u32 s92, s92, 393216
    s_cmp_eq_u32 s92, 7864320
    s_cselect_b32 s92, 0, s92
    s_waitcnt vmcnt(9)
    s_barrier
    s_add_u32 m0, s61, 36864
    s_nop 0
    buffer_load_dwordx4 v220, s[32:35], s92 offen  lds
    s_add_u32 m0, s61, 37888
    s_nop 0
    buffer_load_dwordx4 v221, s[32:35], s92 offen  lds
    s_add_u32 m0, s61, 38912
    s_nop 0
    buffer_load_dwordx4 v222, s[32:35], s92 offen  lds
    s_add_u32 s92, s92, 393216
    s_cmp_eq_u32 s92, 7864320
    s_cselect_b32 s92, 0, s92
    s_add_u32 m0, s61, 49152
    s_nop 0
    buffer_load_dwordx4 v223, s[28:31], s93 offen  lds
    s_add_u32 m0, s61, 50176
    s_nop 0
    buffer_load_dwordx4 v224, s[28:31], s93 offen  lds
    s_add_u32 m0, s61, 51200
    s_nop 0
    buffer_load_dwordx4 v225, s[28:31], s93 offen  lds
    s_add_u32 s93, s93, 128
    s_cmp_eq_u32 s93, 1280
    s_cselect_b32 s93, 0, s93
    s_add_u32 m0, s63, 86016
    s_mov_b32 s56, 0
    buffer_load_dwordx4 v226, s[36:39], s56 offen nt lds
    s_add_u32 m0, s63, 87040
    s_mov_b32 s56, 0
    buffer_load_dwordx4 v227, s[36:39], s56 offen nt lds
    s_add_u32 m0, s63, 88064
    s_mov_b32 s56, 0
    buffer_load_dwordx4 v228, s[36:39], s56 offen nt lds
    s_add_u32 m0, s63, 89088
    s_mov_b32 s56, 3072
    buffer_load_dwordx4 v229, s[36:39], s56 offen nt lds
    s_add_u32 m0, s63, 90112
    s_mov_b32 s56, 3072
    buffer_load_dwordx4 v230, s[36:39], s56 offen nt lds
    s_add_u32 m0, s63, 91136
    s_mov_b32 s56, 3072
    buffer_load_dwordx4 v231, s[36:39], s56 offen nt lds
    s_add_u32 m0, s63, 92160
    s_mov_b32 s56, 6144
    buffer_load_dwordx4 v226, s[36:39], s56 offen nt lds
    s_add_u32 m0, s63, 93184
    s_mov_b32 s56, 6144
    buffer_load_dwordx4 v227, s[36:39], s56 offen nt lds
    s_add_u32 m0, s63, 94208
    s_mov_b32 s56, 6144
    buffer_load_dwordx4 v228, s[36:39], s56 offen nt lds
    s_waitcnt vmcnt(21)
    s_barrier
    s_add_u32 m0, s61, 0
    s_nop 0
    buffer_load_dwordx4 v220, s[32:35], s92 offen  lds
    s_add_u32 m0, s61, 1024
    s_nop 0
    buffer_load_dwordx4 v221, s[32:35], s92 offen  lds
    s_add_u32 m0, s61, 2048
    s_nop 0
    buffer_load_dwordx4 v222, s[32:35], s92 offen  lds
    s_add_u32 s92, s92, 393216
    s_cmp_eq_u32 s92, 7864320
    s_cselect_b32 s92, 0, s92
    s_waitcnt vmcnt(18)
    s_barrier
    s_add_u32 m0, s61, 12288
    s_nop 0
    buffer_load_dwordx4 v220, s[32:35], s92 offen  lds
    s_add_u32 m0, s61, 13312
    s_nop 0
    buffer_load_dwordx4 v221, s[32:35], s92 offen  lds
    s_add_u32 m0, s61, 14336
    s_nop 0
    buffer_load_dwordx4 v222, s[32:35], s92 offen  lds
    s_add_u32 s92, s92, 393216
    s_cmp_eq_u32 s92, 7864320
    s_cselect_b32 s92, 0, s92
    s_add_u32 m0, s61, 61440
    s_nop 0
    buffer_load_dwordx4 v223, s[28:31], s93 offen  lds
    s_add_u32 m0, s61, 62464
    s_nop 0
    buffer_load_dwordx4 v224, s[28:31], s93 offen  lds
    s_add_u32 m0, s61, 63488
    s_nop 0
    buffer_load_dwordx4 v225, s[28:31], s93 offen  lds
    s_add_u32 s93, s93, 128
    s_cmp_eq_u32 s93, 1280
    s_cselect_b32 s93, 0, s93
    s_waitcnt vmcnt(21)
    s_barrier
    s_add_u32 m0, s61, 24576
    s_nop 0
    buffer_load_dwordx4 v220, s[32:35], s92 offen  lds
    s_add_u32 m0, s61, 25600
    s_nop 0
    buffer_load_dwordx4 v221, s[32:35], s92 offen  lds
    s_add_u32 m0, s61, 26624
    s_nop 0
    buffer_load_dwordx4 v222, s[32:35], s92 offen  lds
    s_add_u32 s92, s92, 393216
    s_cmp_eq_u32 s92, 7864320
    s_cselect_b32 s92, 0, s92
    s_waitcnt vmcnt(9)
    s_barrier
    s_add_u32 m0, s61, 36864
    s_nop 0
    buffer_load_dwordx4 v220, s[32:35], s92 offen  lds
    s_add_u32 m0, s61, 37888
    s_nop 0
    buffer_load_dwordx4 v221, s[32:35], s92 offen  lds
    s_add_u32 m0, s61, 38912
    s_nop 0
    buffer_load_dwordx4 v222, s[32:35], s92 offen  lds
    s_add_u32 s92, s92, 393216
    s_cmp_eq_u32 s92, 7864320
    s_cselect_b32 s92, 0, s92
    s_add_u32 m0, s61, 73728
    s_nop 0
    buffer_load_dwordx4 v223, s[28:31], s93 offen  lds
    s_add_u32 m0, s61, 74752
    s_nop 0
    buffer_load_dwordx4 v224, s[28:31], s93 offen  lds
    s_add_u32 m0, s61, 75776
    s_nop 0
    buffer_load_dwordx4 v225, s[28:31], s93 offen  lds
    s_add_u32 s93, s93, 128
    s_cmp_eq_u32 s93, 1280
    s_cselect_b32 s93, 0, s93
    s_waitcnt vmcnt(12)
    s_barrier
    s_add_u32 m0, s61, 0
    s_nop 0
    buffer_load_dwordx4 v220, s[32:35], s92 offen  lds
    s_add_u32 m0, s61, 1024
    s_nop 0
    buffer_load_dwordx4 v221, s[32:35], s92 offen  lds
    s_add_u32 m0, s61, 2048
    s_nop 0
    buffer_load_dwordx4 v222, s[32:35], s92 offen  lds
    s_add_u32 s92, s92, 393216
    s_cmp_eq_u32 s92, 7864320
    s_cselect_b32 s92, 0, s92
    s_waitcnt vmcnt(9)
    s_barrier
    s_add_u32 m0, s61, 12288
    s_nop 0
    buffer_load_dwordx4 v220, s[32:35], s92 offen  lds
    s_add_u32 m0, s61, 13312
    s_nop 0
    buffer_load_dwordx4 v221, s[32:35], s92 offen  lds
    s_add_u32 m0, s61, 14336
    s_nop 0
    buffer_load_dwordx4 v222, s[32:35], s92 offen  lds
    s_add_u32 s92, s92, 393216
    s_cmp_eq_u32 s92, 7864320
    s_cselect_b32 s92, 0, s92
    s_add_u32 m0, s61, 49152
    s_nop 0
    buffer_load_dwordx4 v223, s[28:31], s93 offen  lds
    s_add_u32 m0, s61, 50176
    s_nop 0
    buffer_load_dwordx4 v224, s[28:31], s93 offen  lds
    s_add_u32 m0, s61, 51200
    s_nop 0
    buffer_load_dwordx4 v225, s[28:31], s93 offen  lds
    s_add_u32 s93, s93, 128
    s_cmp_eq_u32 s93, 1280
    s_cselect_b32 s93, 0, s93
    s_waitcnt vmcnt(12)
    s_barrier
    s_add_u32 m0, s61, 24576
    s_nop 0
    buffer_load_dwordx4 v220, s[32:35], s92 offen  lds
    s_add_u32 m0, s61, 25600
    s_nop 0
    buffer_load_dwordx4 v221, s[32:35], s92 offen  lds
    s_add_u32 m0, s61, 26624
    s_nop 0
    buffer_load_dwordx4 v222, s[32:35], s92 offen  lds
    s_add_u32 s92, s92, 393216
    s_cmp_eq_u32 s92, 7864320
    s_cselect_b32 s92, 0, s92
    v_and_b32 v8, 7, v0
    v_lshlrev_b32 v8, 2, v8
    s_lshl_b32 s27, s22, 5
    v_add_u32 v8, s27, v8
    s_cmp_lg_u32 s20, 7
    s_cbranch_scc1 L_nohsrd1
    buffer_load_dword v9, v8, s[68:71], 0 offen sc1
L_nohsrd1:
    s_waitcnt vmcnt(9)
    s_barrier
    s_add_u32 m0, s61, 36864
    s_nop 0
    buffer_load_dwordx4 v220, s[32:35], s92 offen  lds
    s_add_u32 m0, s61, 37888
    s_nop 0
    buffer_load_dwordx4 v221, s[32:35], s92 offen  lds
    s_add_u32 m0, s61, 38912
    s_nop 0
    buffer_load_dwordx4 v222, s[32:35], s92 offen  lds
    s_add_u32 s92, s92, 393216
    s_cmp_eq_u32 s92, 7864320
    s_cselect_b32 s92, 0, s92
    s_waitcnt vmcnt(9)
    s_barrier
    s_add_u32 m0, s63, 122880
    s_mov_b32 s56, 0
    buffer_load_dwordx4 v232, s[40:43], s56 offen nt lds
    s_add_u32 m0, s63, 123904
    s_mov_b32 s56, 0
    buffer_load_dwordx4 v233, s[40:43], s56 offen nt lds
    s_add_u32 m0, s63, 124928
    s_mov_b32 s56, 0
    buffer_load_dwordx4 v234, s[40:43], s56 offen nt lds
    s_add_u32 m0, s63, 125952
    s_mov_b32 s56, 3072
    buffer_load_dwordx4 v232, s[40:43], s56 offen nt lds
    s_add_u32 m0, s63, 126976
    s_mov_b32 s56, 3072
    buffer_load_dwordx4 v233, s[40:43], s56 offen nt lds
    s_add_u32 m0, s63, 128000
    s_mov_b32 s56, 3072
    buffer_load_dwordx4 v234, s[40:43], s56 offen nt lds
    s_add_u32 m0, s63, 129024
    s_mov_b32 s56, 6144
    buffer_load_dwordx4 v232, s[40:43], s56 offen nt lds
    s_add_u32 m0, s63, 130048
    s_mov_b32 s56, 6144
    buffer_load_dwordx4 v233, s[40:43], s56 offen nt lds
    s_add_u32 m0, s63, 131072
    s_mov_b32 s56, 6144
    buffer_load_dwordx4 v234, s[40:43], s56 offen nt lds
    s_waitcnt vmcnt(12)
    s_barrier
    s_waitcnt vmcnt(9)
    s_barrier
    s_branch L_kvjoin
L_kvvar1:
    s_waitcnt vmcnt(12)
    s_barrier
    s_add_u32 m0, s61, 0
    s_nop 0
    buffer_load_dwordx4 v220, s[32:35], s92 offen  lds
    s_add_u32 m0, s61, 1024
    s_nop 0
    buffer_load_dwordx4 v221, s[32:35], s92 offen  lds
    s_add_u32 m0, s61, 2048
    s_nop 0
    buffer_load_dwordx4 v222, s[32:35], s92 offen  lds
    s_add_u32 s92, s92, 393216
    s_cmp_eq_u32 s92, 7864320
    s_cselect_b32 s92, 0, s92
    s_waitcnt vmcnt(9)
    s_barrier
    s_add_u32 m0, s61, 12288
    s_nop 0
    buffer_load_dwordx4 v220, s[32:35], s92 offen  lds
    s_add_u32 m0, s61, 13312
    s_nop 0
    buffer_load_dwordx4 v221, s[32:35], s92 offen  lds
    s_add_u32 m0, s61, 14336
    s_nop 0
    buffer_load_dwordx4 v222, s[32:35], s92 offen  lds
    s_add_u32 s92, s92, 393216
    s_cmp_eq_u32 s92, 7864320
    s_cselect_b32 s92, 0, s92
    s_add_u32 m0, s61, 49152
    s_nop 0
    buffer_load_dwordx4 v223, s[28:31], s93 offen  lds
    s_add_u32 m0, s61, 50176
    s_nop 0
    buffer_load_dwordx4 v224, s[28:31], s93 offen  lds
    s_add_u32 m0, s61, 51200
    s_nop 0
    buffer_load_dwordx4 v225, s[28:31], s93 offen  lds
    s_add_u32 s93, s93, 128
    s_cmp_eq_u32 s93, 1280
    s_cselect_b32 s93, 0, s93
    s_waitcnt vmcnt(12)
    s_barrier
    s_add_u32 m0, s61, 24576
    s_nop 0
    buffer_load_dwordx4 v220, s[32:35], s92 offen  lds
    s_add_u32 m0, s61, 25600
    s_nop 0
    buffer_load_dwordx4 v221, s[32:35], s92 offen  lds
    s_add_u32 m0, s61, 26624
    s_nop 0
    buffer_load_dwordx4 v222, s[32:35], s92 offen  lds
    s_add_u32 s92, s92, 393216
    s_cmp_eq_u32 s92, 7864320
    s_cselect_b32 s92, 0, s92
    s_waitcnt vmcnt(9)
    s_barrier
    s_add_u32 m0, s61, 36864
    s_nop 0
    buffer_load_dwordx4 v220, s[32:35], s92 offen  lds
    s_add_u32 m0, s61, 37888
    s_nop 0
    buffer_load_dwordx4 v221, s[32:35], s92 offen  lds
    s_add_u32 m0, s61, 38912
    s_nop 0
    buffer_load_dwordx4 v222, s[32:35], s92 offen  lds
    s_add_u32 s92, s92, 393216
    s_cmp_eq_u32 s92, 7864320
    s_cselect_b32 s92, 0, s92
    s_add_u32 m0, s61, 61440
    s_nop 0
    buffer_load_dwordx4 v223, s[28:31], s93 offen  lds
    s_add_u32 m0, s61, 62464
    s_nop 0
    buffer_load_dwordx4 v224, s[28:31], s93 offen  lds
    s_add_u32 m0, s61, 63488
    s_nop 0
    buffer_load_dwordx4 v225, s[28:31], s93 offen  lds
    s_add_u32 s93, s93, 128
    s_cmp_eq_u32 s93, 1280
    s_cselect_b32 s93, 0, s93
    s_waitcnt vmcnt(12)
    s_barrier
    s_add_u32 m0, s61, 0
    s_nop 0
    buffer_load_dwordx4 v220, s[32:35], s92 offen  lds
    s_add_u32 m0, s61, 1024
    s_nop 0
    buffer_load_dwordx4 v221, s[32:35], s92 offen  lds
    s_add_u32 m0, s61, 2048
    s_nop 0
    buffer_load_dwordx4 v222, s[32:35], s92 offen  lds
    s_add_u32 s92, s92, 393216
    s_cmp_eq_u32 s92, 7864320
    s_cselect_b32 s92, 0, s92
    s_waitcnt vmcnt(9)
    s_barrier
    s_add_u32 m0, s61, 12288
    s_nop 0
    buffer_load_dwordx4 v220, s[32:35], s92 offen  lds
    s_add_u32 m0, s61, 13312
    s_nop 0
    buffer_load_dwordx4 v221, s[32:35], s92 offen  lds
    s_add_u32 m0, s61, 14336
    s_nop 0
    buffer_load_dwordx4 v222, s[32:35], s92 offen  lds
    s_add_u32 s92, s92, 393216
    s_cmp_eq_u32 s92, 7864320
    s_cselect_b32 s92, 0, s92
    s_add_u32 m0, s61, 73728
    s_nop 0
    buffer_load_dwordx4 v223, s[28:31], s93 offen  lds
    s_add_u32 m0, s61, 74752
    s_nop 0
    buffer_load_dwordx4 v224, s[28:31], s93 offen  lds
    s_add_u32 m0, s61, 75776
    s_nop 0
    buffer_load_dwordx4 v225, s[28:31], s93 offen  lds
    s_add_u32 s93, s93, 128
    s_cmp_eq_u32 s93, 1280
    s_cselect_b32 s93, 0, s93
    s_waitcnt vmcnt(12)
    s_barrier
    s_add_u32 m0, s61, 24576
    s_nop 0
    buffer_load_dwordx4 v220, s[32:35], s92 offen  lds
    s_add_u32 m0, s61, 25600
    s_nop 0
    buffer_load_dwordx4 v221, s[32:35], s92 offen  lds
    s_add_u32 m0, s61, 26624
    s_nop 0
    buffer_load_dwordx4 v222, s[32:35], s92 offen  lds
    s_add_u32 s92, s92, 393216
    s_cmp_eq_u32 s92, 7864320
    s_cselect_b32 s92, 0, s92
    s_waitcnt vmcnt(9)
    s_barrier
    s_add_u32 m0, s61, 36864
    s_nop 0
    buffer_load_dwordx4 v220, s[32:35], s92 offen  lds
    s_add_u32 m0, s61, 37888
    s_nop 0
    buffer_load_dwordx4 v221, s[32:35], s92 offen  lds
    s_add_u32 m0, s61, 38912
    s_nop 0
    buffer_load_dwordx4 v222, s[32:35], s92 offen  lds
    s_add_u32 s92, s92, 393216
    s_cmp_eq_u32 s92, 7864320
    s_cselect_b32 s92, 0, s92
    s_add_u32 m0, s61, 49152
    s_nop 0
    buffer_load_dwordx4 v223, s[28:31], s93 offen  lds
    s_add_u32 m0, s61, 50176
    s_nop 0
    buffer_load_dwordx4 v224, s[28:31], s93 offen  lds
    s_add_u32 m0, s61, 51200
    s_nop 0
    buffer_load_dwordx4 v225, s[28:31], s93 offen  lds
    s_add_u32 s93, s93, 128
    s_cmp_eq_u32 s93, 1280
    s_cselect_b32 s93, 0, s93
    s_waitcnt vmcnt(12)
    s_barrier
    s_add_u32 m0, s61, 0
    s_nop 0
    buffer_load_dwordx4 v220, s[32:35], s92 offen  lds
    s_add_u32 m0, s61, 1024
    s_nop 0
    buffer_load_dwordx4 v221, s[32:35], s92 offen  lds
    s_add_u32 m0, s61, 2048
    s_nop 0
    buffer_load_dwordx4 v222, s[32:35], s92 offen  lds
    s_add_u32 s92, s92, 393216
    s_cmp_eq_u32 s92, 7864320
    s_cselect_b32 s92, 0, s92
    s_waitcnt vmcnt(9)
    s_barrier
    s_add_u32 m0, s61, 12288
    s_nop 0
    buffer_load_dwordx4 v220, s[32:35], s92 offen  lds
    s_add_u32 m0, s61, 13312
    s_nop 0
    buffer_load_dwordx4 v221, s[32:35], s92 offen  lds
    s_add_u32 m0, s61, 14336
    s_nop 0
    buffer_load_dwordx4 v222, s[32:35], s92 offen  lds
    s_add_u32 s92, s92, 393216
    s_cmp_eq_u32 s92, 7864320
    s_cselect_b32 s92, 0, s92
    s_add_u32 m0, s61, 61440
    s_nop 0
    buffer_load_dwordx4 v223, s[28:31], s93 offen  lds
    s_add_u32 m0, s61, 62464
    s_nop 0
    buffer_load_dwordx4 v224, s[28:31], s93 offen  lds
    s_add_u32 m0, s61, 63488
    s_nop 0
    buffer_load_dwordx4 v225, s[28:31], s93 offen  lds
    s_add_u32 s93, s93, 128
    s_cmp_eq_u32 s93, 1280
    s_cselect_b32 s93, 0, s93
    s_waitcnt vmcnt(12)
    s_barrier
    s_add_u32 m0, s61, 24576
    s_nop 0
    buffer_load_dwordx4 v220, s[32:35], s92 offen  lds
    s_add_u32 m0, s61, 25600
    s_nop 0
    buffer_load_dwordx4 v221, s[32:35], s92 offen  lds
    s_add_u32 m0, s61, 26624
    s_nop 0
    buffer_load_dwordx4 v222, s[32:35], s92 offen  lds
    s_add_u32 s92, s92, 393216
    s_cmp_eq_u32 s92, 7864320
    s_cselect_b32 s92, 0, s92
    s_waitcnt vmcnt(9)
    s_barrier
    s_add_u32 m0, s61, 36864
    s_nop 0
    buffer_load_dwordx4 v220, s[32:35], s92 offen  lds
    s_add_u32 m0, s61, 37888
    s_nop 0
    buffer_load_dwordx4 v221, s[32:35], s92 offen  lds
    s_add_u32 m0, s61, 38912
    s_nop 0
    buffer_load_dwordx4 v222, s[32:35], s92 offen  lds
    s_add_u32 s92, s92, 393216
    s_cmp_eq_u32 s92, 7864320
    s_cselect_b32 s92, 0, s92
    s_add_u32 m0, s61, 73728
    s_nop 0
    buffer_load_dwordx4 v223, s[28:31], s93 offen  lds
    s_add_u32 m0, s61, 74752
    s_nop 0
    buffer_load_dwordx4 v224, s[28:31], s93 offen  lds
    s_add_u32 m0, s61, 75776
    s_nop 0
    buffer_load_dwordx4 v225, s[28:31], s93 offen  lds
    s_add_u32 s93, s93, 128
    s_cmp_eq_u32 s93, 1280
    s_cselect_b32 s93, 0, s93
    s_add_u32 m0, s63, 86016
    s_mov_b32 s56, 0
    buffer_load_dwordx4 v226, s[36:39], s56 offen nt lds
    s_add_u32 m0, s63, 87040
    s_mov_b32 s56, 0
    buffer_load_dwordx4 v227, s[36:39], s56 offen nt lds
    s_add_u32 m0, s63, 88064
    s_mov_b32 s56, 0
    buffer_load_dwordx4 v228, s[36:39], s56 offen nt lds
    s_add_u32 m0, s63, 89088
    s_mov_b32 s56, 3072
    buffer_load_dwordx4 v229, s[36:39], s56 offen nt lds
    s_add_u32 m0, s63, 90112
    s_mov_b32 s56, 3072
    buffer_load_dwordx4 v230, s[36:39], s56 offen nt lds
    s_add_u32 m0, s63, 91136
    s_mov_b32 s56, 3072
    buffer_load_dwordx4 v231, s[36:39], s56 offen nt lds
    s_add_u32 m0, s63, 92160
    s_mov_b32 s56, 6144
    buffer_load_dwordx4 v226, s[36:39], s56 offen nt lds
    s_add_u32 m0, s63, 93184
    s_mov_b32 s56, 6144
    buffer_load_dwordx4 v227, s[36:39], s56 offen nt lds
    s_add_u32 m0, s63, 94208
    s_mov_b32 s56, 6144
    buffer_load_dwordx4 v228, s[36:39], s56 offen nt lds
    s_waitcnt vmcnt(21)
    s_barrier
    s_add_u32 m0, s61, 0
    s_nop 0
    buffer_load_dwordx4 v220, s[32:35], s92 offen  lds
    s_add_u32 m0, s61, 1024
    s_nop 0
    buffer_load_dwordx4 v221, s[32:35], s92 offen  lds
    s_add_u32 m0, s61, 2048
    s_nop 0
    buffer_load_dwordx4 v222, s[32:35], s92 offen  lds
    s_add_u32 s92, s92, 393216
    s_cmp_eq_u32 s92, 7864320
    s_cselect_b32 s92, 0, s92
    s_waitcnt vmcnt(18)
    s_barrier
    s_add_u32 m0, s61, 12288
    s_nop 0
    buffer_load_dwordx4 v220, s[32:35], s92 offen  lds
    s_add_u32 m0, s61, 13312
    s_nop 0
    buffer_load_dwordx4 v221, s[32:35], s92 offen  lds
    s_add_u32 m0, s61, 14336
    s_nop 0
    buffer_load_dwordx4 v222, s[32:35], s92 offen  lds
    s_add_u32 s92, s92, 393216
    s_cmp_eq_u32 s92, 7864320
    s_cselect_b32 s92, 0, s92
    s_add_u32 m0, s61, 49152
    s_nop 0
    buffer_load_dwordx4 v223, s[28:31], s93 offen  lds
    s_add_u32 m0, s61, 50176
    s_nop 0
    buffer_load_dwordx4 v224, s[28:31], s93 offen  lds
    s_add_u32 m0, s61, 51200
    s_nop 0
    buffer_load_dwordx4 v225, s[28:31], s93 offen  lds
    s_add_u32 s93, s93, 128
    s_cmp_eq_u32 s93, 1280
    s_cselect_b32 s93, 0, s93
    s_waitcnt vmcnt(21)
    s_barrier
    s_add_u32 m0, s61, 24576
    s_nop 0
    buffer_load_dwordx4 v220, s[32:35], s92 offen  lds
    s_add_u32 m0, s61, 25600
    s_nop 0
    buffer_load_dwordx4 v221, s[32:35], s92 offen  lds
    s_add_u32 m0, s61, 26624
    s_nop 0
    buffer_load_dwordx4 v222, s[32:35], s92 offen  lds
    s_add_u32 s92, s92, 393216
    s_cmp_eq_u32 s92, 7864320
    s_cselect_b32 s92, 0, s92
    v_and_b32 v8, 7, v0
    v_lshlrev_b32 v8, 2, v8
    s_lshl_b32 s27, s22, 5
    v_add_u32 v8, s27, v8
    s_cmp_lg_u32 s20, 7
    s_cbranch_scc1 L_nohsrd2
    buffer_load_dword v9, v8, s[68:71], 0 offen sc1
L_nohsrd2:
    s_waitcnt vmcnt(9)
    s_barrier
    s_add_u32 m0, s61, 36864
    s_nop 0
    buffer_load_dwordx4 v220, s[32:35], s92 offen  lds
    s_add_u32 m0, s61, 37888
    s_nop 0
    buffer_load_dwordx4 v221, s[32:35], s92 offen  lds
    s_add_u32 m0, s61, 38912
    s_nop 0
    buffer_load_dwordx4 v222, s[32:35], s92 offen  lds
    s_add_u32 s92, s92, 393216
    s_cmp_eq_u32 s92, 7864320
    s_cselect_b32 s92, 0, s92
    s_waitcnt vmcnt(9)
    s_barrier
    s_add_u32 m0, s63, 122880
    s_mov_b32 s56, 0
    buffer_load_dwordx4 v232, s[40:43], s56 offen nt lds
    s_add_u32 m0, s63, 123904
    s_mov_b32 s56, 0
    buffer_load_dwordx4 v233, s[40:43], s56 offen nt lds
    s_add_u32 m0, s63, 124928
    s_mov_b32 s56, 0
    buffer_load_dwordx4 v234, s[40:43], s56 offen nt lds
    s_add_u32 m0, s63, 125952
    s_mov_b32 s56, 3072
    buffer_load_dwordx4 v232, s[40:43], s56 offen nt lds
    s_add_u32 m0, s63, 126976
    s_mov_b32 s56, 3072
    buffer_load_dwordx4 v233, s[40:43], s56 offen nt lds
    s_add_u32 m0, s63, 128000
    s_mov_b32 s56, 3072
    buffer_load_dwordx4 v234, s[40:43], s56 offen nt lds
    s_add_u32 m0, s63, 129024
    s_mov_b32 s56, 6144
    buffer_load_dwordx4 v232, s[40:43], s56 offen nt lds
    s_add_u32 m0, s63, 130048
    s_mov_b32 s56, 6144
    buffer_load_dwordx4 v233, s[40:43], s56 offen nt lds
    s_add_u32 m0, s63, 131072
    s_mov_b32 s56, 6144
    buffer_load_dwordx4 v234, s[40:43], s56 offen nt lds
    s_waitcnt vmcnt(12)
    s_barrier
    s_waitcnt vmcnt(9)
    s_barrier
L_kvjoin:
    s_barrier
    buffer_load_dword v253, v251, s[48:51], 0 offen
    s_add_u32 s59, s73, s77
    s_add_u32 m0, s78, 36864
    s_nop 0
    buffer_load_dwordx4 v241, s[48:51], s59 offen  lds
    s_add_u32 m0, s78, 37888
    s_nop 0
    buffer_load_dwordx4 v242, s[48:51], s59 offen  lds
    s_add_u32 m0, s78, 38912
    s_nop 0
    buffer_load_dwordx4 v243, s[48:51], s59 offen  lds
    s_add_u32 m0, s78, 39936
    s_nop 0
    buffer_load_dwordx4 v244, s[48:51], s59 offen  lds
    s_add_u32 m0, s78, 40960
    s_nop 0
    buffer_load_dwordx4 v245, s[48:51], s59 offen  lds
    s_add_u32 s73, s73, 81920
    s_cmp_eq_u32 s73, 983040
    s_cselect_b32 s73, 0, s73
    s_cmp_lg_u32 s20, 7
    s_cbranch_scc1 L_nohs
    v_and_b32 v4, 7, v9
    v_cmp_eq_u32 vcc, 4, v4
    s_nop 1
    s_cmp_eq_u64 vcc, -1
    s_cbranch_scc1 L_hsok
    s_mov_b32 s27, 0
poll3:
    buffer_load_dword v9, v8, s[68:71], 0 offen sc1
    s_waitcnt vmcnt(0)
    v_and_b32 v4, 7, v9
    v_cmp_eq_u32 vcc, 4, v4
    s_nop 1
    s_cmp_eq_u64 vcc, -1
    s_cbranch_scc1 poll3_ok
    s_add_u32 s27, s27, 1
    s_cmp_ge_u32 s27, 400000
    s_cbranch_scc1 poll3_ok
    s_branch poll3
poll3_ok:
L_hsok:
    s_cmp_lg_u32 s20, 7
    s_cbranch_scc1 L_nohs
    v_readlane_b32 s57, v9, s21
    s_nop 1
    s_bfe_u32 s57, s57, 0x100004
    s_and_b32 s58, s57, 15
    s_mul_i32 s58, s58, 0x1111
    s_cmp_eq_u32 s57, s58
    s_cselect_b32 s57, 1, 0
    v_mov_b32 v2, 159744
    v_mov_b32 v3, s57
    ds_write_b32 v2, v3
    buffer_load_dword v253, v249, s[44:47], 0 offen sc1
    s_waitcnt lgkmcnt(0)
L_nohs:
    s_waitcnt vmcnt(6)
    s_barrier
    s_add_u32 s59, s73, s77
    s_add_u32 m0, s78, 57344
    s_nop 0
    buffer_load_dwordx4 v241, s[48:51], s59 offen  lds
    s_add_u32 m0, s78, 58368
    s_nop 0
    buffer_load_dwordx4 v242, s[48:51], s59 offen  lds
    s_add_u32 m0, s78, 59392
    s_nop 0
    buffer_load_dwordx4 v243, s[48:51], s59 offen  lds
    s_add_u32 m0, s78, 60416
    s_nop 0
    buffer_load_dwordx4 v244, s[48:51], s59 offen  lds
    s_add_u32 m0, s78, 61440
    s_nop 0
    buffer_load_dwordx4 v245, s[48:51], s59 offen  lds
    s_add_u32 s73, s73, 81920
    s_cmp_eq_u32 s73, 983040
    s_cselect_b32 s73, 0, s73
    s_add_u32 s59, s73, s77
    s_add_u32 m0, s78, 77824
    s_nop 0
    buffer_load_dwordx4 v241, s[48:51], s59 offen  lds
    s_add_u32 m0, s78, 78848
    s_nop 0
    buffer_load_dwordx4 v242, s[48:51], s59 offen  lds
    s_add_u32 m0, s78, 79872
    s_nop 0
    buffer_load_dwordx4 v243, s[48:51], s59 offen  lds
    s_add_u32 m0, s78, 80896
    s_nop 0
    buffer_load_dwordx4 v244, s[48:51], s59 offen  lds
    s_add_u32 m0, s78, 81920
    s_nop 0
    buffer_load_dwordx4 v245, s[48:51], s59 offen  lds
    s_add_u32 s73, s73, 81920
    s_cmp_eq_u32 s73, 983040
    s_cselect_b32 s73, 0, s73
    s_add_u32 s59, s73, s77
    s_add_u32 m0, s78, 98304
    s_nop 0
    buffer_load_dwordx4 v241, s[48:51], s59 offen  lds
    s_add_u32 m0, s78, 99328
    s_nop 0
    buffer_load_dwordx4 v242, s[48:51], s59 offen  lds
    s_add_u32 m0, s78, 100352
    s_nop 0
    buffer_load_dwordx4 v243, s[48:51], s59 offen  lds
    s_add_u32 m0, s78, 101376
    s_nop 0
    buffer_load_dwordx4 v244, s[48:51], s59 offen  lds
    s_add_u32 m0, s78, 102400
    s_nop 0
    buffer_load_dwordx4 v245, s[48:51], s59 offen  lds
    s_add_u32 s73, s73, 81920
    s_cmp_eq_u32 s73, 983040
    s_cselect_b32 s73, 0, s73
    s_waitcnt vmcnt(15)
    s_barrier
    s_waitcnt vmcnt(10)
    s_barrier
    s_add_u32 s59, s73, s77
    s_add_u32 m0, s78, 36864
    s_nop 0
    buffer_load_dwordx4 v241, s[48:51], s59 offen  lds
    s_add_u32 m0, s78, 37888
    s_nop 0
    buffer_load_dwordx4 v242, s[48:51], s59 offen  lds
    s_add_u32 m0, s78, 38912
    s_nop 0
    buffer_load_dwordx4 v243, s[48:51], s59 offen  lds
    s_add_u32 m0, s78, 39936
    s_nop 0
    buffer_load_dwordx4 v244, s[48:51], s59 offen  lds
    s_add_u32 m0, s78, 40960
    s_nop 0
    buffer_load_dwordx4 v245, s[48:51], s59 offen  lds
    s_add_u32 s73, s73, 81920
    s_cmp_eq_u32 s73, 983040
    s_cselect_b32 s73, 0, s73
    s_waitcnt vmcnt(10)
    s_barrier
    s_add_u32 s59, s73, s77
    s_add_u32 m0, s78, 57344
    s_nop 0
    buffer_load_dwordx4 v241, s[48:51], s59 offen  lds
    s_add_u32 m0, s78, 58368
    s_nop 0
    buffer_load_dwordx4 v242, s[48:51], s59 offen  lds
    s_add_u32 m0, s78, 59392
    s_nop 0
    buffer_load_dwordx4 v243, s[48:51], s59 offen  lds
    s_add_u32 m0, s78, 60416
    s_nop 0
    buffer_load_dwordx4 v244, s[48:51], s59 offen  lds
    s_add_u32 m0, s78, 61440
    s_nop 0
    buffer_load_dwordx4 v245, s[48:51], s59 offen  lds
    s_add_u32 s73, s73, 81920
    s_cmp_eq_u32 s73, 983040
    s_cselect_b32 s73, 0, s73
    s_mov_b32 s27, 0
poll4:
    buffer_load_dword v3, v249, s[44:47], 0 offen sc1
    s_waitcnt vmcnt(0)
    v_cmp_eq_u32 vcc, 1, v3
    s_nop 1
    s_cmp_eq_u64 vcc, -1
    s_cbranch_scc1 poll4_ok
    s_add_u32 s27, s27, 1
    s_cmp_ge_u32 s27, 400000
    s_cbranch_scc1 poll4_ok
    s_branch poll4
poll4_ok:
    s_add_u32 m0, s74, 122880
    s_nop 0
    buffer_load_dwordx4 v246, s[44:47], s75 offen offset:0 sc1 lds
    buffer_load_dwordx4 v246, s[44:47], s75 offen offset:1024 sc1 lds
    buffer_load_dwordx4 v246, s[44:47], s75 offen offset:2048 sc1 lds
    s_add_u32 s75, s75, 12288
    s_cmp_eq_u32 s75, 147456
    s_cselect_b32 s75, 0, s75
    s_add_u32 m0, s74, 135168
    s_nop 0
    buffer_load_dwordx4 v246, s[44:47], s75 offen offset:0 sc1 lds
    buffer_load_dwordx4 v246, s[44:47], s75 offen offset:1024 sc1 lds
    buffer_load_dwordx4 v246, s[44:47], s75 offen offset:2048 sc1 lds
    s_add_u32 s75, s75, 12288
    s_cmp_eq_u32 s75, 147456
    s_cselect_b32 s75, 0, s75
    s_add_u32 m0, s74, 147456
    s_nop 0
    buffer_load_dwordx4 v246, s[44:47], s75 offen offset:0 sc1 lds
    buffer_load_dwordx4 v246, s[44:47], s75 offen offset:1024 sc1 lds
    buffer_load_dwordx4 v246, s[44:47], s75 offen offset:2048 sc1 lds
    s_add_u32 s75, s75, 12288
    s_cmp_eq_u32 s75, 147456
    s_cselect_b32 s75, 0, s75
    s_waitcnt vmcnt(6)
    s_barrier
    s_add_u32 s59, s73, s77
    s_add_u32 m0, s78, 77824
    s_nop 0
    buffer_load_dwordx4 v241, s[48:51], s59 offen  lds
    s_add_u32 m0, s78, 78848
    s_nop 0
    buffer_load_dwordx4 v242, s[48:51], s59 offen  lds
    s_add_u32 m0, s78, 79872
    s_nop 0
    buffer_load_dwordx4 v243, s[48:51], s59 offen  lds
    s_add_u32 m0, s78, 80896
    s_nop 0
    buffer_load_dwordx4 v244, s[48:51], s59 offen  lds
    s_add_u32 m0, s78, 81920
    s_nop 0
    buffer_load_dwordx4 v245, s[48:51], s59 offen  lds
    s_add_u32 s73, s73, 81920
    s_cmp_eq_u32 s73, 983040
    s_cselect_b32 s73, 0, s73
    s_waitcnt vmcnt(8)
    s_barrier
    s_add_u32 s59, s73, s77
    s_add_u32 m0, s78, 98304
    s_nop 0
    buffer_load_dwordx4 v241, s[48:51], s59 offen  lds
    s_add_u32 m0, s78, 99328
    s_nop 0
    buffer_load_dwordx4 v242, s[48:51], s59 offen  lds
    s_add_u32 m0, s78, 100352
    s_nop 0
    buffer_load_dwordx4 v243, s[48:51], s59 offen  lds
    s_add_u32 m0, s78, 101376
    s_nop 0
    buffer_load_dwordx4 v244, s[48:51], s59 offen  lds
    s_add_u32 m0, s78, 102400
    s_nop 0
    buffer_load_dwordx4 v245, s[48:51], s59 offen  lds
    s_add_u32 s73, s73, 81920
    s_cmp_eq_u32 s73, 983040
    s_cselect_b32 s73, 0, s73
    s_add_u32 m0, s74, 122880
    s_nop 0
    buffer_load_dwordx4 v246, s[44:47], s75 offen offset:0 sc1 lds
    buffer_load_dwordx4 v246, s[44:47], s75 offen offset:1024 sc1 lds
    buffer_load_dwordx4 v246, s[44:47], s75 offen offset:2048 sc1 lds
    s_add_u32 s75, s75, 12288
    s_cmp_eq_u32 s75, 147456
    s_cselect_b32 s75, 0, s75
    s_waitcnt vmcnt(13)
    s_barrier
    s_add_u32 s59, s73, s77
    s_add_u32 m0, s78, 36864
    s_nop 0
    buffer_load_dwordx4 v241, s[48:51], s59 offen  lds
    s_add_u32 m0, s78, 37888
    s_nop 0
    buffer_load_dwordx4 v242, s[48:51], s59 offen  lds
    s_add_u32 m0, s78, 38912
    s_nop 0
    buffer_load_dwordx4 v243, s[48:51], s59 offen  lds
    s_add_u32 m0, s78, 39936
    s_nop 0
    buffer_load_dwordx4 v244, s[48:51], s59 offen  lds
    s_add_u32 m0, s78, 40960
    s_nop 0
    buffer_load_dwordx4 v245, s[48:51], s59 offen  lds
    s_add_u32 s73, s73, 81920
    s_cmp_eq_u32 s73, 983040
    s_cselect_b32 s73, 0, s73
    s_add_u32 m0, s74, 135168
    s_nop 0
    buffer_load_dwordx4 v246, s[44:47], s75 offen offset:0 sc1 lds
    buffer_load_dwordx4 v246, s[44:47], s75 offen offset:1024 sc1 lds
    buffer_load_dwordx4 v246, s[44:47], s75 offen offset:2048 sc1 lds
    s_add_u32 s75, s75, 12288
    s_cmp_eq_u32 s75, 147456
    s_cselect_b32 s75, 0, s75
    s_waitcnt vmcnt(8)
    s_barrier
    s_add_u32 s59, s73, s77
    s_add_u32 m0, s78, 57344
    s_nop 0
    buffer_load_dwordx4 v241, s[48:51], s59 offen  lds
    s_add_u32 m0, s78, 58368
    s_nop 0
    buffer_load_dwordx4 v242, s[48:51], s59 offen  lds
    s_add_u32 m0, s78, 59392
    s_nop 0
    buffer_load_dwordx4 v243, s[48:51], s59 offen  lds
    s_add_u32 m0, s78, 60416
    s_nop 0
    buffer_load_dwordx4 v244, s[48:51], s59 offen  lds
    s_add_u32 m0, s78, 61440
    s_nop 0
    buffer_load_dwordx4 v245, s[48:51], s59 offen  lds
    s_add_u32 s73, s73, 81920
    s_cmp_eq_u32 s73, 983040
    s_cselect_b32 s73, 0, s73
    s_add_u32 m0, s74, 147456
    s_nop 0
    buffer_load_dwordx4 v246, s[44:47], s75 offen offset:0 sc1 lds
    buffer_load_dwordx4 v246, s[44:47], s75 offen offset:1024 sc1 lds
    buffer_load_dwordx4 v246, s[44:47], s75 offen offset:2048 sc1 lds
    s_add_u32 s75, s75, 12288
    s_cmp_eq_u32 s75, 147456
    s_cselect_b32 s75, 0, s75
    s_waitcnt vmcnt(8)
    s_barrier
    s_add_u32 s59, s73, s77
    s_add_u32 m0, s78, 77824
    s_nop 0
    buffer_load_dwordx4 v241, s[48:51], s59 offen  lds
    s_add_u32 m0, s78, 78848
    s_nop 0
    buffer_load_dwordx4 v242, s[48:51], s59 offen  lds
    s_add_u32 m0, s78, 79872
    s_nop 0
    buffer_load_dwordx4 v243, s[48:51], s59 offen  lds
    s_add_u32 m0, s78, 80896
    s_nop 0
    buffer_load_dwordx4 v244, s[48:51], s59 offen  lds
    s_add_u32 m0, s78, 81920
    s_nop 0
    buffer_load_dwordx4 v245, s[48:51], s59 offen  lds
    s_add_u32 s73, s73, 81920
    s_cmp_eq_u32 s73, 983040
    s_cselect_b32 s73, 0, s73
    s_add_u32 m0, s74, 122880
    s_nop 0
    buffer_load_dwordx4 v246, s[44:47], s75 offen offset:0 sc1 lds
    buffer_load_dwordx4 v246, s[44:47], s75 offen offset:1024 sc1 lds
    buffer_load_dwordx4 v246, s[44:47], s75 offen offset:2048 sc1 lds
    s_add_u32 s75, s75, 12288
    s_cmp_eq_u32 s75, 147456
    s_cselect_b32 s75, 0, s75
    s_waitcnt vmcnt(8)
    s_barrier
    s_add_u32 s59, s73, s77
    s_add_u32 m0, s78, 98304
    s_nop 0
    buffer_load_dwordx4 v241, s[48:51], s59 offen  lds
    s_add_u32 m0, s78, 99328
    s_nop 0
    buffer_load_dwordx4 v242, s[48:51], s59 offen  lds
    s_add_u32 m0, s78, 100352
    s_nop 0
    buffer_load_dwordx4 v243, s[48:51], s59 offen  lds
    s_add_u32 m0, s78, 101376
    s_nop 0
    buffer_load_dwordx4 v244, s[48:51], s59 offen  lds
    s_add_u32 m0, s78, 102400
    s_nop 0
    buffer_load_dwordx4 v245, s[48:51], s59 offen  lds
    s_add_u32 m0, s74, 135168
    s_nop 0
    buffer_load_dwordx4 v246, s[44:47], s75 offen offset:0 sc1 lds
    buffer_load_dwordx4 v246, s[44:47], s75 offen offset:1024 sc1 lds
    buffer_load_dwordx4 v246, s[44:47], s75 offen offset:2048 sc1 lds
    s_add_u32 s75, s75, 12288
    s_cmp_eq_u32 s75, 147456
    s_cselect_b32 s75, 0, s75
    s_waitcnt vmcnt(8)
    s_barrier
    s_add_u32 m0, s74, 147456
    s_nop 0
    buffer_load_dwordx4 v246, s[44:47], s75 offen offset:0 sc1 lds
    buffer_load_dwordx4 v246, s[44:47], s75 offen offset:1024 sc1 lds
    buffer_load_dwordx4 v246, s[44:47], s75 offen offset:2048 sc1 lds
    s_waitcnt vmcnt(3)
    s_barrier
    s_waitcnt vmcnt(0)
    s_barrier
    s_barrier
    s_lshl_b32 s56, s60, 10
    v_lshlrev_b32 v2, 4, v0
    v_add_u32 v2, s56, v2
    ds_read_b128 v[16:19], v2 offset:0
    s_cmp_lg_u32 s20, 4
    s_cbranch_scc1 L_nopoll2
    s_mov_b32 s27, 0
poll5:
    buffer_load_dword v3, v250, s[44:47], 0 offen sc1
    s_waitcnt vmcnt(0)
    v_cmp_eq_u32 vcc, 1, v3
    s_nop 1
    s_cmp_eq_u64 vcc, -1
    s_cbranch_scc1 poll5_ok
    s_add_u32 s27, s27, 1
    s_cmp_ge_u32 s27, 400000
    s_cbranch_scc1 poll5_ok
    s_branch poll5
poll5_ok:
L_nopoll2:
    s_barrier
    s_cmp_eq_u32 s96, 7
    s_cselect_b32 exec_hi, 0, -1
    s_add_u32 s56, s21, 1
    s_and_b32 s56, s56, 7
    s_lshl_b32 s56, s56, 15
    buffer_load_dwordx4 v[20:23], v247, s[44:47], s56 offen sc1
    s_add_u32 s56, s21, 2
    s_and_b32 s56, s56, 7
    s_lshl_b32 s56, s56, 15
    buffer_load_dwordx4 v[24:27], v247, s[44:47], s56 offen sc1
    s_add_u32 s56, s21, 3
    s_and_b32 s56, s56, 7
    s_lshl_b32 s56, s56, 15
    buffer_load_dwordx4 v[28:31], v247, s[44:47], s56 offen sc1
    s_add_u32 s56, s21, 4
    s_and_b32 s56, s56, 7
    s_lshl_b32 s56, s56, 15
    buffer_load_dwordx4 v[32:35], v247, s[44:47], s56 offen sc1
    s_add_u32 s56, s21, 5
    s_and_b32 s56, s56, 7
    s_lshl_b32 s56, s56, 15
    buffer_load_dwordx4 v[36:39], v247, s[44:47], s56 offen sc1
    s_add_u32 s56, s21, 6
    s_and_b32 s56, s56, 7
    s_lshl_b32 s56, s56, 15
    buffer_load_dwordx4 v[40:43], v247, s[44:47], s56 offen sc1
    s_add_u32 s56, s21, 7
    s_and_b32 s56, s56, 7
    s_lshl_b32 s56, s56, 15
    buffer_load_dwordx4 v[44:47], v247, s[44:47], s56 offen sc1
    s_mov_b32 s57, 0xffff0000
    s_waitcnt lgkmcnt(0)
    v_lshlrev_b32 v48, 16, v16
    v_and_b32 v49, s57, v16
    v_lshlrev_b32 v50, 16, v17
    v_and_b32 v51, s57, v17
    v_lshlrev_b32 v52, 16, v18
    v_and_b32 v53, s57, v18
    v_lshlrev_b32 v54, 16, v19
    v_and_b32 v55, s57, v19
    s_waitcnt vmcnt(6)
    v_lshlrev_b32 v60, 16, v20
    v_and_b32 v61, s57, v20
    v_add_f32 v48, v48, v60
    v_add_f32 v49, v49, v61
    v_lshlrev_b32 v62, 16, v21
    v_and_b32 v63, s57, v21
    v_add_f32 v50, v50, v62
    v_add_f32 v51, v51, v63
    v_lshlrev_b32 v64, 16, v22
    v_and_b32 v65, s57, v22
    v_add_f32 v52, v52, v64
    v_add_f32 v53, v53, v65
    v_lshlrev_b32 v66, 16, v23
    v_and_b32 v67, s57, v23
    v_add_f32 v54, v54, v66
    v_add_f32 v55, v55, v67
    s_waitcnt vmcnt(5)
    v_lshlrev_b32 v60, 16, v24
    v_and_b32 v61, s57, v24
    v_add_f32 v48, v48, v60
    v_add_f32 v49, v49, v61
    v_lshlrev_b32 v62, 16, v25
    v_and_b32 v63, s57, v25
    v_add_f32 v50, v50, v62
    v_add_f32 v51, v51, v63
    v_lshlrev_b32 v64, 16, v26
    v_and_b32 v65, s57, v26
    v_add_f32 v52, v52, v64
    v_add_f32 v53, v53, v65
    v_lshlrev_b32 v66, 16, v27
    v_and_b32 v67, s57, v27
    v_add_f32 v54, v54, v66
    v_add_f32 v55, v55, v67
    s_waitcnt vmcnt(4)
    v_lshlrev_b32 v60, 16, v28
    v_and_b32 v61, s57, v28
    v_add_f32 v48, v48, v60
    v_add_f32 v49, v49, v61
    v_lshlrev_b32 v62, 16, v29
    v_and_b32 v63, s57, v29
    v_add_f32 v50, v50, v62
    v_add_f32 v51, v51, v63
    v_lshlrev_b32 v64, 16, v30
    v_and_b32 v65, s57, v30
    v_add_f32 v52, v52, v64
    v_add_f32 v53, v53, v65
    v_lshlrev_b32 v66, 16, v31
    v_and_b32 v67, s57, v31
    v_add_f32 v54, v54, v66
    v_add_f32 v55, v55, v67
    s_waitcnt vmcnt(3)
    v_lshlrev_b32 v60, 16, v32
    v_and_b32 v61, s57, v32
    v_add_f32 v48, v48, v60
    v_add_f32 v49, v49, v61
    v_lshlrev_b32 v62, 16, v33
    v_and_b32 v63, s57, v33
    v_add_f32 v50, v50, v62
    v_add_f32 v51, v51, v63
    v_lshlrev_b32 v64, 16, v34
    v_and_b32 v65, s57, v34
    v_add_f32 v52, v52, v64
    v_add_f32 v53, v53, v65
    v_lshlrev_b32 v66, 16, v35
    v_and_b32 v67, s57, v35
    v_add_f32 v54, v54, v66
    v_add_f32 v55, v55, v67
    s_waitcnt vmcnt(2)
    v_lshlrev_b32 v60, 16, v36
    v_and_b32 v61, s57, v36
    v_add_f32 v48, v48, v60
    v_add_f32 v49, v49, v61
    v_lshlrev_b32 v62, 16, v37
    v_and_b32 v63, s57, v37
    v_add_f32 v50, v50, v62
    v_add_f32 v51, v51, v63
    v_lshlrev_b32 v64, 16, v38
    v_and_b32 v65, s57, v38
    v_add_f32 v52, v52, v64
    v_add_f32 v53, v53, v65
    v_lshlrev_b32 v66, 16, v39
    v_and_b32 v67, s57, v39
    v_add_f32 v54, v54, v66
    v_add_f32 v55, v55, v67
    s_waitcnt vmcnt(1)
    v_lshlrev_b32 v60, 16, v40
    v_and_b32 v61, s57, v40
    v_add_f32 v48, v48, v60
    v_add_f32 v49, v49, v61
    v_lshlrev_b32 v62, 16, v41
    v_and_b32 v63, s57, v41
    v_add_f32 v50, v50, v62
    v_add_f32 v51, v51, v63
    v_lshlrev_b32 v64, 16, v42
    v_and_b32 v65, s57, v42
    v_add_f32 v52, v52, v64
    v_add_f32 v53, v53, v65
    v_lshlrev_b32 v66, 16, v43
    v_and_b32 v67, s57, v43
    v_add_f32 v54, v54, v66
    v_add_f32 v55, v55, v67
    s_waitcnt vmcnt(0)
    v_lshlrev_b32 v60, 16, v44
    v_and_b32 v61, s57, v44
    v_add_f32 v48, v48, v60
    v_add_f32 v49, v49, v61
    v_lshlrev_b32 v62, 16, v45
    v_and_b32 v63, s57, v45
    v_add_f32 v50, v50, v62
    v_add_f32 v51, v51, v63
    v_lshlrev_b32 v64, 16, v46
    v_and_b32 v65, s57, v46
    v_add_f32 v52, v52, v64
    v_add_f32 v53, v53, v65
    v_lshlrev_b32 v66, 16, v47
    v_and_b32 v67, s57, v47
    v_add_f32 v54, v54, v66
    v_add_f32 v55, v55, v67
    v_cvt_pk_bf16_f32 v16, v48, v49
    v_cvt_pk_bf16_f32 v17, v50, v51
    v_cvt_pk_bf16_f32 v18, v52, v53
    v_cvt_pk_bf16_f32 v19, v54, v55
    buffer_store_dwordx2 v[16:17], v248, s[52:55], 0 offen
    buffer_store_dwordx2 v[18:19], v248, s[52:55], s97 offen
    s_mov_b64 exec, -1
    s_branch L_fin
L_computeA:
    s_mov_b32 s66, 0
    v_lshrrev_b32 v2, 4, v0
    v_bfe_u32 v3, v0, 2, 2
    v_and_b32 v4, 3, v0
    v_and_b32 v5, 15, v0
    v_lshlrev_b32 v6, 3, v2
    v_add_u32 v6, v6, v3
    v_mul_u32_u24 v6, 384, v6
    v_lshl_add_u32 v6, v4, 3, v6
    v_lshrrev_b32 v7, 1, v3
    v_and_b32 v8, 1, v2
    v_lshl_or_b32 v7, v8, 1, v7
    s_mul_i32 s56, s20, 3
    s_add_u32 s57, s56, 0
    v_xor_b32 v8, s57, v7
    v_lshl_add_u32 v10, v8, 5, v6
    s_add_u32 s57, s56, 1
    v_xor_b32 v8, s57, v7
    v_lshl_add_u32 v11, v8, 5, v6
    s_add_u32 s57, s56, 2
    v_xor_b32 v8, s57, v7
    v_lshl_add_u32 v12, v8, 5, v6
    v_lshrrev_b32 v6, 1, v5
    v_xor_b32 v6, v6, v2
    v_lshlrev_b32 v6, 4, v6
    v_lshl_add_u32 v6, v5, 7, v6
    v_add_u32 v13, 49152, v6
    v_xor_b32 v14, 64, v13
    v_lshrrev_b32 v6, 1, v2
    v_lshlrev_b32 v6, 9, v6
    v_lshl_add_u32 v6, v5, 4, v6
    v_and_b32 v7, 1, v2
    v_lshl_add_u32 v6, v7, 3, v6
    s_mul_i32 s56, s20, 3072
    v_add_u32 v15, s56, v6
    v_lshlrev_b32 v240, 4, v0
    v_mov_b32 v252, 1
    v_and_b32 v6, 31, v0
    v_lshrrev_b32 v7, 5, v0
    v_bfe_u32 v8, v0, 1, 3
    v_xor_b32 v8, v8, v7
    v_mul_u32_u24 v9, 384, v6
    v_lshl_add_u32 v9, v8, 4, v9
    v_add_u32 v232, 86016, v9
    v_lshl_add_u32 v8, v7, 2, v3
    v_mul_u32_u24 v8, 384, v8
    v_lshl_add_u32 v8, v4, 3, v8
    v_and_b32 v9, 2, v3
    v_and_b32 v6, 1, v2
    v_or_b32 v9, v9, v6
    v_lshl_add_u32 v8, v9, 5, v8
    v_add_u32 v233, 122880, v8
    v_lshlrev_b32 v8, 10, v6
    v_lshl_add_u32 v8, v7, 8, v8
    v_lshl_add_u32 v8, v5, 4, v8
    s_lshl_b32 s56, s20, 11
    v_add_u32 v234, s56, v8
    s_lshl_b32 s58, s22, 3
    s_add_u32 s58, s58, s21
    s_lshl_b32 s58, s58, 2
    s_add_u32 s58, s58, s23
    s_mul_i32 s62, s58, 36864
    s_add_u32 s62, s62, 234881024
    s_lshl_b32 s58, s23, 11
    s_sub_u32 s58, s76, s58
    s_add_u32 s58, s58, 1024
    s_mul_i32 s59, s23, 12
    s_add_u32 s58, s58, s59
    s_lshl_b32 s59, s20, 2
    s_add_u32 s58, s58, s59
    v_lshlrev_b32 v8, 11, v4
    v_add_u32 v241, s58, v8
    s_and_b32 s64, s20, 1
    s_lshr_b32 s65, s20, 1
    v_lshrrev_b32 v6, 1, v2
    v_lshlrev_b32 v6, 4, v6
    v_and_b32 v7, 1, v2
    v_lshl_add_u32 v6, v7, 2, v6
    v_add_u32 v6, v6, v3
    v_mul_u32_u24 v6, 320, v6
    v_lshl_add_u32 v6, v4, 3, v6
    v_add_u32 v6, 36864, v6
    s_mul_i32 s56, s64, 5
    s_add_u32 s57, s64, 0
    s_add_u32 s57, s57, s56
    v_xor_b32 v8, s57, v7
    v_lshl_add_u32 v235, v8, 5, v6
    s_add_u32 s57, s64, 1
    s_add_u32 s57, s57, s56
    v_xor_b32 v8, s57, v7
    v_lshl_add_u32 v236, v8, 5, v6
    s_add_u32 s57, s64, 2
    s_add_u32 s57, s57, s56
    v_xor_b32 v8, s57, v7
    v_lshl_add_u32 v237, v8, 5, v6
    s_add_u32 s57, s64, 3
    s_add_u32 s57, s57, s56
    v_xor_b32 v8, s57, v7
    v_lshl_add_u32 v238, v8, 5, v6
    s_add_u32 s57, s64, 4
    s_cmp_eq_u32 s57, 5
    s_cselect_b32 s57, 0, s57
    s_add_u32 s57, s57, s56
    v_xor_b32 v8, s57, v7
    v_lshl_add_u32 v239, v8, 5, v6
    s_lshl_b32 s56, s22, 2
    s_add_u32 s56, s56, s23
    s_lshl_b32 s56, s56, 3
    s_add_u32 s56, s56, s21
    s_lshl_b32 s56, s56, 2
    s_add_u32 s56, s56, s20
    s_lshl_b32 s56, s56, 13
    s_add_u32 s67, s56, 251658240
    s_lshl_b32 s56, s22, 5
    s_lshl_b32 s57, s20, 3
    s_add_u32 s56, s56, s57
    s_add_u32 s56, s56, s23
    s_lshl_b32 s56, s56, 11
    s_lshl_b32 s57, s21, 7
    s_add_u32 s56, s56, s57
    s_add_u32 s56, s56, 264241152
    v_bfe_u32 v3, v0, 3, 1
    v_lshlrev_b32 v3, 13, v3
    v_and_b32 v6, 7, v0
    v_lshl_add_u32 v3, v6, 4, v3
    v_add_u32 v242, s56, v3
    s_waitcnt lgkmcnt(0)
    s_mov_b32 s44, s18
    s_and_b32 s45, s19, 0xffff
    s_mov_b32 s46, 268435456
    s_mov_b32 s47, 0x20000
    s_cmp_lg_u32 s20, 3
    s_cbranch_scc1 L_noclr
    s_mov_b32 s68, s16
    s_and_b32 s69, s17, 0xffff
    s_mov_b32 s70, 256
    s_mov_b32 s71, 0x20000
    v_lshlrev_b32 v2, 4, v0
    v_mov_b32 v4, 0
    v_mov_b32 v5, 0
    v_mov_b32 v6, 0
    v_mov_b32 v7, 0
    buffer_store_dwordx4 v[4:7], v2, s[44:47], s76 offen sc0 sc1
    s_mov_b64 exec, 0xff
    buffer_store_dwordx4 v[4:7], v2, s[44:47], s76 offen offset:1024 sc0 sc1
    s_mov_b64 exec, -1
    s_waitcnt vmcnt(0)
    s_getreg_b32 s57, hwreg(HW_REG_XCC_ID, 0, 4)
    s_lshl_b32 s58, s23, 2
    s_add_u32 s58, s58, 4
    s_lshl_b32 s57, s57, s58
    s_add_u32 s57, s57, 1
    s_lshl_b32 s58, s22, 3
    s_add_u32 s58, s58, s21
    s_lshl_b32 s58, s58, 2
    v_mov_b32 v2, s57
    v_mov_b32 v3, s58
    s_mov_b64 exec, 1
    buffer_atomic_add v2, v3, s[68:71], 0 offen sc1
    s_mov_b64 exec, -1
L_noclr:
    s_barrier
    ds_read_b64_tr_b16 v[88:89], v10 offset:0
    ds_read_b64_tr_b16 v[90:91], v10 offset:1536
    ds_read_b128 v[100:103], v13 offset:0
    ds_read_b128 v[104:107], v13 offset:2048
    ds_read_b128 v[108:111], v13 offset:4096
    ds_read_b128 v[112:115], v13 offset:6144
    ds_read_b128 v[116:119], v13 offset:8192
    ds_read_b128 v[120:123], v13 offset:10240
    ds_read_b64_tr_b16 v[92:93], v11 offset:0
    ds_read_b64_tr_b16 v[94:95], v11 offset:1536
    ds_read_b64_tr_b16 v[96:97], v12 offset:0
    ds_read_b64_tr_b16 v[98:99], v12 offset:1536
    s_waitcnt lgkmcnt(0)
    s_barrier
    v_mfma_f32_16x16x32_bf16 v[16:19], v[88:91], v[100:103], 0
    ds_read_b64_tr_b16 v[124:125], v10 offset:12288
    v_mfma_f32_16x16x32_bf16 v[20:23], v[88:91], v[104:107], 0
    ds_read_b64_tr_b16 v[126:127], v10 offset:13824
    v_mfma_f32_16x16x32_bf16 v[24:27], v[88:91], v[108:111], 0
    ds_read_b128 v[136:139], v14 offset:0
    v_mfma_f32_16x16x32_bf16 v[28:31], v[88:91], v[112:115], 0
    ds_read_b128 v[140:143], v14 offset:2048
    v_mfma_f32_16x16x32_bf16 v[32:35], v[88:91], v[116:119], 0
    ds_read_b128 v[144:147], v14 offset:4096
    v_mfma_f32_16x16x32_bf16 v[36:39], v[88:91], v[120:123], 0
    ds_read_b128 v[148:151], v14 offset:6144
    v_mfma_f32_16x16x32_bf16 v[40:43], v[92:95], v[100:103], 0
    ds_read_b128 v[152:155], v14 offset:8192
    v_mfma_f32_16x16x32_bf16 v[44:47], v[92:95], v[104:107], 0
    ds_read_b128 v[156:159], v14 offset:10240
    v_mfma_f32_16x16x32_bf16 v[48:51], v[92:95], v[108:111], 0
    ds_read_b64_tr_b16 v[128:129], v11 offset:12288
    v_mfma_f32_16x16x32_bf16 v[52:55], v[92:95], v[112:115], 0
    ds_read_b64_tr_b16 v[130:131], v11 offset:13824
    v_mfma_f32_16x16x32_bf16 v[56:59], v[92:95], v[116:119], 0
    ds_read_b64_tr_b16 v[132:133], v12 offset:12288
    v_mfma_f32_16x16x32_bf16 v[60:63], v[92:95], v[120:123], 0
    ds_read_b64_tr_b16 v[134:135], v12 offset:13824
    v_mfma_f32_16x16x32_bf16 v[64:67], v[96:99], v[100:103], 0
    v_mfma_f32_16x16x32_bf16 v[68:71], v[96:99], v[104:107], 0
    v_mfma_f32_16x16x32_bf16 v[72:75], v[96:99], v[108:111], 0
    v_mfma_f32_16x16x32_bf16 v[76:79], v[96:99], v[112:115], 0
    v_mfma_f32_16x16x32_bf16 v[80:83], v[96:99], v[116:119], 0
    v_mfma_f32_16x16x32_bf16 v[84:87], v[96:99], v[120:123], 0
    s_waitcnt lgkmcnt(0)
    s_barrier
    v_mfma_f32_16x16x32_bf16 v[16:19], v[124:127], v[136:139], v[16:19]
    ds_read_b64_tr_b16 v[88:89], v10 offset:24576
    v_mfma_f32_16x16x32_bf16 v[20:23], v[124:127], v[140:143], v[20:23]
    ds_read_b64_tr_b16 v[90:91], v10 offset:26112
    v_mfma_f32_16x16x32_bf16 v[24:27], v[124:127], v[144:147], v[24:27]
    ds_read_b128 v[100:103], v13 offset:12288
    v_mfma_f32_16x16x32_bf16 v[28:31], v[124:127], v[148:151], v[28:31]
    ds_read_b128 v[104:107], v13 offset:14336
    v_mfma_f32_16x16x32_bf16 v[32:35], v[124:127], v[152:155], v[32:35]
    ds_read_b128 v[108:111], v13 offset:16384
    v_mfma_f32_16x16x32_bf16 v[36:39], v[124:127], v[156:159], v[36:39]
    ds_read_b128 v[112:115], v13 offset:18432
    v_mfma_f32_16x16x32_bf16 v[40:43], v[128:131], v[136:139], v[40:43]
    ds_read_b128 v[116:119], v13 offset:20480
    v_mfma_f32_16x16x32_bf16 v[44:47], v[128:131], v[140:143], v[44:47]
    ds_read_b128 v[120:123], v13 offset:22528
    v_mfma_f32_16x16x32_bf16 v[48:51], v[128:131], v[144:147], v[48:51]
    ds_read_b64_tr_b16 v[92:93], v11 offset:24576
    v_mfma_f32_16x16x32_bf16 v[52:55], v[128:131], v[148:151], v[52:55]
    ds_read_b64_tr_b16 v[94:95], v11 offset:26112
    v_mfma_f32_16x16x32_bf16 v[56:59], v[128:131], v[152:155], v[56:59]
    ds_read_b64_tr_b16 v[96:97], v12 offset:24576
    v_mfma_f32_16x16x32_bf16 v[60:63], v[128:131], v[156:159], v[60:63]
    ds_read_b64_tr_b16 v[98:99], v12 offset:26112
    v_mfma_f32_16x16x32_bf16 v[64:67], v[132:135], v[136:139], v[64:67]
    v_mfma_f32_16x16x32_bf16 v[68:71], v[132:135], v[140:143], v[68:71]
    v_mfma_f32_16x16x32_bf16 v[72:75], v[132:135], v[144:147], v[72:75]
    v_mfma_f32_16x16x32_bf16 v[76:79], v[132:135], v[148:151], v[76:79]
    v_mfma_f32_16x16x32_bf16 v[80:83], v[132:135], v[152:155], v[80:83]
    v_mfma_f32_16x16x32_bf16 v[84:87], v[132:135], v[156:159], v[84:87]
    s_waitcnt lgkmcnt(0)
    s_barrier
    v_mfma_f32_16x16x32_bf16 v[16:19], v[88:91], v[100:103], v[16:19]
    ds_read_b64_tr_b16 v[124:125], v10 offset:36864
    v_mfma_f32_16x16x32_bf16 v[20:23], v[88:91], v[104:107], v[20:23]
    ds_read_b64_tr_b16 v[126:127], v10 offset:38400
    v_mfma_f32_16x16x32_bf16 v[24:27], v[88:91], v[108:111], v[24:27]
    ds_read_b128 v[136:139], v14 offset:12288
    v_mfma_f32_16x16x32_bf16 v[28:31], v[88:91], v[112:115], v[28:31]
    ds_read_b128 v[140:143], v14 offset:14336
    v_mfma_f32_16x16x32_bf16 v[32:35], v[88:91], v[116:119], v[32:35]
    ds_read_b128 v[144:147], v14 offset:16384
    v_mfma_f32_16x16x32_bf16 v[36:39], v[88:91], v[120:123], v[36:39]
    ds_read_b128 v[148:151], v14 offset:18432
    v_mfma_f32_16x16x32_bf16 v[40:43], v[92:95], v[100:103], v[40:43]
    ds_read_b128 v[152:155], v14 offset:20480
    v_mfma_f32_16x16x32_bf16 v[44:47], v[92:95], v[104:107], v[44:47]
    ds_read_b128 v[156:159], v14 offset:22528
    v_mfma_f32_16x16x32_bf16 v[48:51], v[92:95], v[108:111], v[48:51]
    ds_read_b64_tr_b16 v[128:129], v11 offset:36864
    v_mfma_f32_16x16x32_bf16 v[52:55], v[92:95], v[112:115], v[52:55]
    ds_read_b64_tr_b16 v[130:131], v11 offset:38400
    v_mfma_f32_16x16x32_bf16 v[56:59], v[92:95], v[116:119], v[56:59]
    ds_read_b64_tr_b16 v[132:133], v12 offset:36864
    v_mfma_f32_16x16x32_bf16 v[60:63], v[92:95], v[120:123], v[60:63]
    ds_read_b64_tr_b16 v[134:135], v12 offset:38400
    v_mfma_f32_16x16x32_bf16 v[64:67], v[96:99], v[100:103], v[64:67]
    v_mfma_f32_16x16x32_bf16 v[68:71], v[96:99], v[104:107], v[68:71]
    v_mfma_f32_16x16x32_bf16 v[72:75], v[96:99], v[108:111], v[72:75]
    v_mfma_f32_16x16x32_bf16 v[76:79], v[96:99], v[112:115], v[76:79]
    v_mfma_f32_16x16x32_bf16 v[80:83], v[96:99], v[116:119], v[80:83]
    v_mfma_f32_16x16x32_bf16 v[84:87], v[96:99], v[120:123], v[84:87]
    s_waitcnt lgkmcnt(0)
    s_barrier
    v_mfma_f32_16x16x32_bf16 v[16:19], v[124:127], v[136:139], v[16:19]
    ds_read_b64_tr_b16 v[88:89], v10 offset:0
    v_mfma_f32_16x16x32_bf16 v[20:23], v[124:127], v[140:143], v[20:23]
    ds_read_b64_tr_b16 v[90:91], v10 offset:1536
    v_mfma_f32_16x16x32_bf16 v[24:27], v[124:127], v[144:147], v[24:27]
    ds_read_b128 v[100:103], v13 offset:24576
    v_mfma_f32_16x16x32_bf16 v[28:31], v[124:127], v[148:151], v[28:31]
    ds_read_b128 v[104:107], v13 offset:26624
    v_mfma_f32_16x16x32_bf16 v[32:35], v[124:127], v[152:155], v[32:35]
    ds_read_b128 v[108:111], v13 offset:28672
    v_mfma_f32_16x16x32_bf16 v[36:39], v[124:127], v[156:159], v[36:39]
    ds_read_b128 v[112:115], v13 offset:30720
    v_mfma_f32_16x16x32_bf16 v[40:43], v[128:131], v[136:139], v[40:43]
    ds_read_b128 v[116:119], v13 offset:32768
    v_mfma_f32_16x16x32_bf16 v[44:47], v[128:131], v[140:143], v[44:47]
    ds_read_b128 v[120:123], v13 offset:34816
    v_mfma_f32_16x16x32_bf16 v[48:51], v[128:131], v[144:147], v[48:51]
    ds_read_b64_tr_b16 v[92:93], v11 offset:0
    v_mfma_f32_16x16x32_bf16 v[52:55], v[128:131], v[148:151], v[52:55]
    ds_read_b64_tr_b16 v[94:95], v11 offset:1536
    v_mfma_f32_16x16x32_bf16 v[56:59], v[128:131], v[152:155], v[56:59]
    ds_read_b64_tr_b16 v[96:97], v12 offset:0
    v_mfma_f32_16x16x32_bf16 v[60:63], v[128:131], v[156:159], v[60:63]
    ds_read_b64_tr_b16 v[98:99], v12 offset:1536
    v_mfma_f32_16x16x32_bf16 v[64:67], v[132:135], v[136:139], v[64:67]
    v_mfma_f32_16x16x32_bf16 v[68:71], v[132:135], v[140:143], v[68:71]
    v_mfma_f32_16x16x32_bf16 v[72:75], v[132:135], v[144:147], v[72:75]
    v_mfma_f32_16x16x32_bf16 v[76:79], v[132:135], v[148:151], v[76:79]
    v_mfma_f32_16x16x32_bf16 v[80:83], v[132:135], v[152:155], v[80:83]
    v_mfma_f32_16x16x32_bf16 v[84:87], v[132:135], v[156:159], v[84:87]
    s_waitcnt lgkmcnt(0)
    s_barrier
    v_mfma_f32_16x16x32_bf16 v[16:19], v[88:91], v[100:103], v[16:19]
    ds_read_b64_tr_b16 v[124:125], v10 offset:12288
    v_mfma_f32_16x16x32_bf16 v[20:23], v[88:91], v[104:107], v[20:23]
    ds_read_b64_tr_b16 v[126:127], v10 offset:13824
    v_mfma_f32_16x16x32_bf16 v[24:27], v[88:91], v[108:111], v[24:27]
    ds_read_b128 v[136:139], v14 offset:24576
    v_mfma_f32_16x16x32_bf16 v[28:31], v[88:91], v[112:115], v[28:31]
    ds_read_b128 v[140:143], v14 offset:26624
    v_mfma_f32_16x16x32_bf16 v[32:35], v[88:91], v[116:119], v[32:35]
    ds_read_b128 v[144:147], v14 offset:28672
    v_mfma_f32_16x16x32_bf16 v[36:39], v[88:91], v[120:123], v[36:39]
    ds_read_b128 v[148:151], v14 offset:30720
    v_mfma_f32_16x16x32_bf16 v[40:43], v[92:95], v[100:103], v[40:43]
    ds_read_b128 v[152:155], v14 offset:32768
    v_mfma_f32_16x16x32_bf16 v[44:47], v[92:95], v[104:107], v[44:47]
    ds_read_b128 v[156:159], v14 offset:34816
    v_mfma_f32_16x16x32_bf16 v[48:51], v[92:95], v[108:111], v[48:51]
    ds_read_b64_tr_b16 v[128:129], v11 offset:12288
    v_mfma_f32_16x16x32_bf16 v[52:55], v[92:95], v[112:115], v[52:55]
    ds_read_b64_tr_b16 v[130:131], v11 offset:13824
    v_mfma_f32_16x16x32_bf16 v[56:59], v[92:95], v[116:119], v[56:59]
    ds_read_b64_tr_b16 v[132:133], v12 offset:12288
    v_mfma_f32_16x16x32_bf16 v[60:63], v[92:95], v[120:123], v[60:63]
    ds_read_b64_tr_b16 v[134:135], v12 offset:13824
    v_mfma_f32_16x16x32_bf16 v[64:67], v[96:99], v[100:103], v[64:67]
    v_mfma_f32_16x16x32_bf16 v[68:71], v[96:99], v[104:107], v[68:71]
    v_mfma_f32_16x16x32_bf16 v[72:75], v[96:99], v[108:111], v[72:75]
    v_mfma_f32_16x16x32_bf16 v[76:79], v[96:99], v[112:115], v[76:79]
    v_mfma_f32_16x16x32_bf16 v[80:83], v[96:99], v[116:119], v[80:83]
    v_mfma_f32_16x16x32_bf16 v[84:87], v[96:99], v[120:123], v[84:87]
    s_waitcnt lgkmcnt(0)
    s_barrier
    v_mfma_f32_16x16x32_bf16 v[16:19], v[124:127], v[136:139], v[16:19]
    ds_read_b64_tr_b16 v[88:89], v10 offset:24576
    v_mfma_f32_16x16x32_bf16 v[20:23], v[124:127], v[140:143], v[20:23]
    ds_read_b64_tr_b16 v[90:91], v10 offset:26112
    v_mfma_f32_16x16x32_bf16 v[24:27], v[124:127], v[144:147], v[24:27]
    ds_read_b128 v[100:103], v13 offset:0
    v_mfma_f32_16x16x32_bf16 v[28:31], v[124:127], v[148:151], v[28:31]
    ds_read_b128 v[104:107], v13 offset:2048
    v_mfma_f32_16x16x32_bf16 v[32:35], v[124:127], v[152:155], v[32:35]
    ds_read_b128 v[108:111], v13 offset:4096
    v_mfma_f32_16x16x32_bf16 v[36:39], v[124:127], v[156:159], v[36:39]
    ds_read_b128 v[112:115], v13 offset:6144
    v_mfma_f32_16x16x32_bf16 v[40:43], v[128:131], v[136:139], v[40:43]
    ds_read_b128 v[116:119], v13 offset:8192
    v_mfma_f32_16x16x32_bf16 v[44:47], v[128:131], v[140:143], v[44:47]
    ds_read_b128 v[120:123], v13 offset:10240
    v_mfma_f32_16x16x32_bf16 v[48:51], v[128:131], v[144:147], v[48:51]
    ds_read_b64_tr_b16 v[92:93], v11 offset:24576
    v_mfma_f32_16x16x32_bf16 v[52:55], v[128:131], v[148:151], v[52:55]
    ds_read_b64_tr_b16 v[94:95], v11 offset:26112
    v_mfma_f32_16x16x32_bf16 v[56:59], v[128:131], v[152:155], v[56:59]
    ds_read_b64_tr_b16 v[96:97], v12 offset:24576
    v_mfma_f32_16x16x32_bf16 v[60:63], v[128:131], v[156:159], v[60:63]
    ds_read_b64_tr_b16 v[98:99], v12 offset:26112
    v_mfma_f32_16x16x32_bf16 v[64:67], v[132:135], v[136:139], v[64:67]
    v_mfma_f32_16x16x32_bf16 v[68:71], v[132:135], v[140:143], v[68:71]
    v_mfma_f32_16x16x32_bf16 v[72:75], v[132:135], v[144:147], v[72:75]
    v_mfma_f32_16x16x32_bf16 v[76:79], v[132:135], v[148:151], v[76:79]
    v_mfma_f32_16x16x32_bf16 v[80:83], v[132:135], v[152:155], v[80:83]
    v_mfma_f32_16x16x32_bf16 v[84:87], v[132:135], v[156:159], v[84:87]
    s_waitcnt lgkmcnt(0)
    s_barrier
    v_mfma_f32_16x16x32_bf16 v[16:19], v[88:91], v[100:103], v[16:19]
    ds_read_b64_tr_b16 v[124:125], v10 offset:36864
    v_mfma_f32_16x16x32_bf16 v[20:23], v[88:91], v[104:107], v[20:23]
    ds_read_b64_tr_b16 v[126:127], v10 offset:38400
    v_mfma_f32_16x16x32_bf16 v[24:27], v[88:91], v[108:111], v[24:27]
    ds_read_b128 v[136:139], v14 offset:0
    v_mfma_f32_16x16x32_bf16 v[28:31], v[88:91], v[112:115], v[28:31]
    ds_read_b128 v[140:143], v14 offset:2048
    v_mfma_f32_16x16x32_bf16 v[32:35], v[88:91], v[116:119], v[32:35]
    ds_read_b128 v[144:147], v14 offset:4096
    v_mfma_f32_16x16x32_bf16 v[36:39], v[88:91], v[120:123], v[36:39]
    ds_read_b128 v[148:151], v14 offset:6144
    v_mfma_f32_16x16x32_bf16 v[40:43], v[92:95], v[100:103], v[40:43]
    ds_read_b128 v[152:155], v14 offset:8192
    v_mfma_f32_16x16x32_bf16 v[44:47], v[92:95], v[104:107], v[44:47]
    ds_read_b128 v[156:159], v14 offset:10240
    v_mfma_f32_16x16x32_bf16 v[48:51], v[92:95], v[108:111], v[48:51]
    ds_read_b64_tr_b16 v[128:129], v11 offset:36864
    v_mfma_f32_16x16x32_bf16 v[52:55], v[92:95], v[112:115], v[52:55]
    ds_read_b64_tr_b16 v[130:131], v11 offset:38400
    v_mfma_f32_16x16x32_bf16 v[56:59], v[92:95], v[116:119], v[56:59]
    ds_read_b64_tr_b16 v[132:133], v12 offset:36864
    v_mfma_f32_16x16x32_bf16 v[60:63], v[92:95], v[120:123], v[60:63]
    ds_read_b64_tr_b16 v[134:135], v12 offset:38400
    v_mfma_f32_16x16x32_bf16 v[64:67], v[96:99], v[100:103], v[64:67]
    v_mfma_f32_16x16x32_bf16 v[68:71], v[96:99], v[104:107], v[68:71]
    v_mfma_f32_16x16x32_bf16 v[72:75], v[96:99], v[108:111], v[72:75]
    v_mfma_f32_16x16x32_bf16 v[76:79], v[96:99], v[112:115], v[76:79]
    v_mfma_f32_16x16x32_bf16 v[80:83], v[96:99], v[116:119], v[80:83]
    v_mfma_f32_16x16x32_bf16 v[84:87], v[96:99], v[120:123], v[84:87]
    s_waitcnt lgkmcnt(0)
    s_barrier
    v_mfma_f32_16x16x32_bf16 v[16:19], v[124:127], v[136:139], v[16:19]
    ds_read_b64_tr_b16 v[88:89], v10 offset:0
    v_mfma_f32_16x16x32_bf16 v[20:23], v[124:127], v[140:143], v[20:23]
    ds_read_b64_tr_b16 v[90:91], v10 offset:1536
    v_mfma_f32_16x16x32_bf16 v[24:27], v[124:127], v[144:147], v[24:27]
    ds_read_b128 v[100:103], v13 offset:12288
    v_mfma_f32_16x16x32_bf16 v[28:31], v[124:127], v[148:151], v[28:31]
    ds_read_b128 v[104:107], v13 offset:14336
    v_mfma_f32_16x16x32_bf16 v[32:35], v[124:127], v[152:155], v[32:35]
    ds_read_b128 v[108:111], v13 offset:16384
    v_mfma_f32_16x16x32_bf16 v[36:39], v[124:127], v[156:159], v[36:39]
    ds_read_b128 v[112:115], v13 offset:18432
    v_mfma_f32_16x16x32_bf16 v[40:43], v[128:131], v[136:139], v[40:43]
    ds_read_b128 v[116:119], v13 offset:20480
    v_mfma_f32_16x16x32_bf16 v[44:47], v[128:131], v[140:143], v[44:47]
    ds_read_b128 v[120:123], v13 offset:22528
    v_mfma_f32_16x16x32_bf16 v[48:51], v[128:131], v[144:147], v[48:51]
    ds_read_b64_tr_b16 v[92:93], v11 offset:0
    v_mfma_f32_16x16x32_bf16 v[52:55], v[128:131], v[148:151], v[52:55]
    ds_read_b64_tr_b16 v[94:95], v11 offset:1536
    v_mfma_f32_16x16x32_bf16 v[56:59], v[128:131], v[152:155], v[56:59]
    ds_read_b64_tr_b16 v[96:97], v12 offset:0
    v_mfma_f32_16x16x32_bf16 v[60:63], v[128:131], v[156:159], v[60:63]
    ds_read_b64_tr_b16 v[98:99], v12 offset:1536
    v_mfma_f32_16x16x32_bf16 v[64:67], v[132:135], v[136:139], v[64:67]
    v_mfma_f32_16x16x32_bf16 v[68:71], v[132:135], v[140:143], v[68:71]
    v_mfma_f32_16x16x32_bf16 v[72:75], v[132:135], v[144:147], v[72:75]
    v_mfma_f32_16x16x32_bf16 v[76:79], v[132:135], v[148:151], v[76:79]
    v_mfma_f32_16x16x32_bf16 v[80:83], v[132:135], v[152:155], v[80:83]
    v_mfma_f32_16x16x32_bf16 v[84:87], v[132:135], v[156:159], v[84:87]
    s_waitcnt lgkmcnt(0)
    s_barrier
    v_mfma_f32_16x16x32_bf16 v[16:19], v[88:91], v[100:103], v[16:19]
    ds_read_b64_tr_b16 v[124:125], v10 offset:12288
    v_mfma_f32_16x16x32_bf16 v[20:23], v[88:91], v[104:107], v[20:23]
    ds_read_b64_tr_b16 v[126:127], v10 offset:13824
    v_mfma_f32_16x16x32_bf16 v[24:27], v[88:91], v[108:111], v[24:27]
    ds_read_b128 v[136:139], v14 offset:12288
    v_mfma_f32_16x16x32_bf16 v[28:31], v[88:91], v[112:115], v[28:31]
    ds_read_b128 v[140:143], v14 offset:14336
    v_mfma_f32_16x16x32_bf16 v[32:35], v[88:91], v[116:119], v[32:35]
    ds_read_b128 v[144:147], v14 offset:16384
    v_mfma_f32_16x16x32_bf16 v[36:39], v[88:91], v[120:123], v[36:39]
    ds_read_b128 v[148:151], v14 offset:18432
    v_mfma_f32_16x16x32_bf16 v[40:43], v[92:95], v[100:103], v[40:43]
    ds_read_b128 v[152:155], v14 offset:20480
    v_mfma_f32_16x16x32_bf16 v[44:47], v[92:95], v[104:107], v[44:47]
    ds_read_b128 v[156:159], v14 offset:22528
    v_mfma_f32_16x16x32_bf16 v[48:51], v[92:95], v[108:111], v[48:51]
    ds_read_b64_tr_b16 v[128:129], v11 offset:12288
    v_mfma_f32_16x16x32_bf16 v[52:55], v[92:95], v[112:115], v[52:55]
    ds_read_b64_tr_b16 v[130:131], v11 offset:13824
    v_mfma_f32_16x16x32_bf16 v[56:59], v[92:95], v[116:119], v[56:59]
    ds_read_b64_tr_b16 v[132:133], v12 offset:12288
    v_mfma_f32_16x16x32_bf16 v[60:63], v[92:95], v[120:123], v[60:63]
    ds_read_b64_tr_b16 v[134:135], v12 offset:13824
    v_mfma_f32_16x16x32_bf16 v[64:67], v[96:99], v[100:103], v[64:67]
    v_mfma_f32_16x16x32_bf16 v[68:71], v[96:99], v[104:107], v[68:71]
    v_mfma_f32_16x16x32_bf16 v[72:75], v[96:99], v[108:111], v[72:75]
    v_mfma_f32_16x16x32_bf16 v[76:79], v[96:99], v[112:115], v[76:79]
    v_mfma_f32_16x16x32_bf16 v[80:83], v[96:99], v[116:119], v[80:83]
    v_mfma_f32_16x16x32_bf16 v[84:87], v[96:99], v[120:123], v[84:87]
    s_waitcnt lgkmcnt(0)
    s_barrier
    v_mfma_f32_16x16x32_bf16 v[16:19], v[124:127], v[136:139], v[16:19]
    ds_read_b64_tr_b16 v[88:89], v10 offset:24576
    v_mfma_f32_16x16x32_bf16 v[20:23], v[124:127], v[140:143], v[20:23]
    ds_read_b64_tr_b16 v[90:91], v10 offset:26112
    v_mfma_f32_16x16x32_bf16 v[24:27], v[124:127], v[144:147], v[24:27]
    ds_read_b128 v[100:103], v13 offset:24576
    v_mfma_f32_16x16x32_bf16 v[28:31], v[124:127], v[148:151], v[28:31]
    ds_read_b128 v[104:107], v13 offset:26624
    v_mfma_f32_16x16x32_bf16 v[32:35], v[124:127], v[152:155], v[32:35]
    ds_read_b128 v[108:111], v13 offset:28672
    v_mfma_f32_16x16x32_bf16 v[36:39], v[124:127], v[156:159], v[36:39]
    ds_read_b128 v[112:115], v13 offset:30720
    v_mfma_f32_16x16x32_bf16 v[40:43], v[128:131], v[136:139], v[40:43]
    ds_read_b128 v[116:119], v13 offset:32768
    v_mfma_f32_16x16x32_bf16 v[44:47], v[128:131], v[140:143], v[44:47]
    ds_read_b128 v[120:123], v13 offset:34816
    v_mfma_f32_16x16x32_bf16 v[48:51], v[128:131], v[144:147], v[48:51]
    ds_read_b64_tr_b16 v[92:93], v11 offset:24576
    v_mfma_f32_16x16x32_bf16 v[52:55], v[128:131], v[148:151], v[52:55]
    ds_read_b64_tr_b16 v[94:95], v11 offset:26112
    v_mfma_f32_16x16x32_bf16 v[56:59], v[128:131], v[152:155], v[56:59]
    ds_read_b64_tr_b16 v[96:97], v12 offset:24576
    v_mfma_f32_16x16x32_bf16 v[60:63], v[128:131], v[156:159], v[60:63]
    ds_read_b64_tr_b16 v[98:99], v12 offset:26112
    v_mfma_f32_16x16x32_bf16 v[64:67], v[132:135], v[136:139], v[64:67]
    v_mfma_f32_16x16x32_bf16 v[68:71], v[132:135], v[140:143], v[68:71]
    v_mfma_f32_16x16x32_bf16 v[72:75], v[132:135], v[144:147], v[72:75]
    v_mfma_f32_16x16x32_bf16 v[76:79], v[132:135], v[148:151], v[76:79]
    v_mfma_f32_16x16x32_bf16 v[80:83], v[132:135], v[152:155], v[80:83]
    v_mfma_f32_16x16x32_bf16 v[84:87], v[132:135], v[156:159], v[84:87]
    s_waitcnt lgkmcnt(0)
    s_barrier
    v_mfma_f32_16x16x32_bf16 v[16:19], v[88:91], v[100:103], v[16:19]
    ds_read_b64_tr_b16 v[124:125], v10 offset:36864
    v_mfma_f32_16x16x32_bf16 v[20:23], v[88:91], v[104:107], v[20:23]
    ds_read_b64_tr_b16 v[126:127], v10 offset:38400
    v_mfma_f32_16x16x32_bf16 v[24:27], v[88:91], v[108:111], v[24:27]
    ds_read_b128 v[136:139], v14 offset:24576
    v_mfma_f32_16x16x32_bf16 v[28:31], v[88:91], v[112:115], v[28:31]
    ds_read_b128 v[140:143], v14 offset:26624
    v_mfma_f32_16x16x32_bf16 v[32:35], v[88:91], v[116:119], v[32:35]
    ds_read_b128 v[144:147], v14 offset:28672
    v_mfma_f32_16x16x32_bf16 v[36:39], v[88:91], v[120:123], v[36:39]
    ds_read_b128 v[148:151], v14 offset:30720
    v_mfma_f32_16x16x32_bf16 v[40:43], v[92:95], v[100:103], v[40:43]
    ds_read_b128 v[152:155], v14 offset:32768
    v_mfma_f32_16x16x32_bf16 v[44:47], v[92:95], v[104:107], v[44:47]
    ds_read_b128 v[156:159], v14 offset:34816
    v_mfma_f32_16x16x32_bf16 v[48:51], v[92:95], v[108:111], v[48:51]
    ds_read_b64_tr_b16 v[128:129], v11 offset:36864
    v_mfma_f32_16x16x32_bf16 v[52:55], v[92:95], v[112:115], v[52:55]
    ds_read_b64_tr_b16 v[130:131], v11 offset:38400
    v_mfma_f32_16x16x32_bf16 v[56:59], v[92:95], v[116:119], v[56:59]
    ds_read_b64_tr_b16 v[132:133], v12 offset:36864
    v_mfma_f32_16x16x32_bf16 v[60:63], v[92:95], v[120:123], v[60:63]
    ds_read_b64_tr_b16 v[134:135], v12 offset:38400
    v_mfma_f32_16x16x32_bf16 v[64:67], v[96:99], v[100:103], v[64:67]
    v_mfma_f32_16x16x32_bf16 v[68:71], v[96:99], v[104:107], v[68:71]
    v_mfma_f32_16x16x32_bf16 v[72:75], v[96:99], v[108:111], v[72:75]
    v_mfma_f32_16x16x32_bf16 v[76:79], v[96:99], v[112:115], v[76:79]
    v_mfma_f32_16x16x32_bf16 v[80:83], v[96:99], v[116:119], v[80:83]
    v_mfma_f32_16x16x32_bf16 v[84:87], v[96:99], v[120:123], v[84:87]
    s_waitcnt lgkmcnt(0)
    s_barrier
    v_mfma_f32_16x16x32_bf16 v[16:19], v[124:127], v[136:139], v[16:19]
    ds_read_b64_tr_b16 v[88:89], v10 offset:0
    v_mfma_f32_16x16x32_bf16 v[20:23], v[124:127], v[140:143], v[20:23]
    ds_read_b64_tr_b16 v[90:91], v10 offset:1536
    v_mfma_f32_16x16x32_bf16 v[24:27], v[124:127], v[144:147], v[24:27]
    ds_read_b128 v[100:103], v13 offset:0
    v_mfma_f32_16x16x32_bf16 v[28:31], v[124:127], v[148:151], v[28:31]
    ds_read_b128 v[104:107], v13 offset:2048
    v_mfma_f32_16x16x32_bf16 v[32:35], v[124:127], v[152:155], v[32:35]
    ds_read_b128 v[108:111], v13 offset:4096
    v_mfma_f32_16x16x32_bf16 v[36:39], v[124:127], v[156:159], v[36:39]
    ds_read_b128 v[112:115], v13 offset:6144
    v_mfma_f32_16x16x32_bf16 v[40:43], v[128:131], v[136:139], v[40:43]
    ds_read_b128 v[116:119], v13 offset:8192
    v_mfma_f32_16x16x32_bf16 v[44:47], v[128:131], v[140:143], v[44:47]
    ds_read_b128 v[120:123], v13 offset:10240
    v_mfma_f32_16x16x32_bf16 v[48:51], v[128:131], v[144:147], v[48:51]
    ds_read_b64_tr_b16 v[92:93], v11 offset:0
    v_mfma_f32_16x16x32_bf16 v[52:55], v[128:131], v[148:151], v[52:55]
    ds_read_b64_tr_b16 v[94:95], v11 offset:1536
    v_mfma_f32_16x16x32_bf16 v[56:59], v[128:131], v[152:155], v[56:59]
    ds_read_b64_tr_b16 v[96:97], v12 offset:0
    v_mfma_f32_16x16x32_bf16 v[60:63], v[128:131], v[156:159], v[60:63]
    ds_read_b64_tr_b16 v[98:99], v12 offset:1536
    v_mfma_f32_16x16x32_bf16 v[64:67], v[132:135], v[136:139], v[64:67]
    v_mfma_f32_16x16x32_bf16 v[68:71], v[132:135], v[140:143], v[68:71]
    v_mfma_f32_16x16x32_bf16 v[72:75], v[132:135], v[144:147], v[72:75]
    v_mfma_f32_16x16x32_bf16 v[76:79], v[132:135], v[148:151], v[76:79]
    v_mfma_f32_16x16x32_bf16 v[80:83], v[132:135], v[152:155], v[80:83]
    v_mfma_f32_16x16x32_bf16 v[84:87], v[132:135], v[156:159], v[84:87]
    s_waitcnt lgkmcnt(0)
    s_barrier
    v_mfma_f32_16x16x32_bf16 v[16:19], v[88:91], v[100:103], v[16:19]
    ds_read_b64_tr_b16 v[124:125], v10 offset:12288
    v_mfma_f32_16x16x32_bf16 v[20:23], v[88:91], v[104:107], v[20:23]
    ds_read_b64_tr_b16 v[126:127], v10 offset:13824
    v_mfma_f32_16x16x32_bf16 v[24:27], v[88:91], v[108:111], v[24:27]
    ds_read_b128 v[136:139], v14 offset:0
    v_mfma_f32_16x16x32_bf16 v[28:31], v[88:91], v[112:115], v[28:31]
    ds_read_b128 v[140:143], v14 offset:2048
    v_mfma_f32_16x16x32_bf16 v[32:35], v[88:91], v[116:119], v[32:35]
    ds_read_b128 v[144:147], v14 offset:4096
    v_mfma_f32_16x16x32_bf16 v[36:39], v[88:91], v[120:123], v[36:39]
    ds_read_b128 v[148:151], v14 offset:6144
    v_mfma_f32_16x16x32_bf16 v[40:43], v[92:95], v[100:103], v[40:43]
    ds_read_b128 v[152:155], v14 offset:8192
    v_mfma_f32_16x16x32_bf16 v[44:47], v[92:95], v[104:107], v[44:47]
    ds_read_b128 v[156:159], v14 offset:10240
    v_mfma_f32_16x16x32_bf16 v[48:51], v[92:95], v[108:111], v[48:51]
    ds_read_b64_tr_b16 v[128:129], v11 offset:12288
    v_mfma_f32_16x16x32_bf16 v[52:55], v[92:95], v[112:115], v[52:55]
    ds_read_b64_tr_b16 v[130:131], v11 offset:13824
    v_mfma_f32_16x16x32_bf16 v[56:59], v[92:95], v[116:119], v[56:59]
    ds_read_b64_tr_b16 v[132:133], v12 offset:12288
    v_mfma_f32_16x16x32_bf16 v[60:63], v[92:95], v[120:123], v[60:63]
    ds_read_b64_tr_b16 v[134:135], v12 offset:13824
    v_mfma_f32_16x16x32_bf16 v[64:67], v[96:99], v[100:103], v[64:67]
    v_mfma_f32_16x16x32_bf16 v[68:71], v[96:99], v[104:107], v[68:71]
    v_mfma_f32_16x16x32_bf16 v[72:75], v[96:99], v[108:111], v[72:75]
    v_mfma_f32_16x16x32_bf16 v[76:79], v[96:99], v[112:115], v[76:79]
    v_mfma_f32_16x16x32_bf16 v[80:83], v[96:99], v[116:119], v[80:83]
    v_mfma_f32_16x16x32_bf16 v[84:87], v[96:99], v[120:123], v[84:87]
    s_waitcnt lgkmcnt(0)
    s_barrier
    v_mfma_f32_16x16x32_bf16 v[16:19], v[124:127], v[136:139], v[16:19]
    ds_read_b64_tr_b16 v[88:89], v10 offset:24576
    v_mfma_f32_16x16x32_bf16 v[20:23], v[124:127], v[140:143], v[20:23]
    ds_read_b64_tr_b16 v[90:91], v10 offset:26112
    v_mfma_f32_16x16x32_bf16 v[24:27], v[124:127], v[144:147], v[24:27]
    ds_read_b128 v[100:103], v13 offset:12288
    v_mfma_f32_16x16x32_bf16 v[28:31], v[124:127], v[148:151], v[28:31]
    ds_read_b128 v[104:107], v13 offset:14336
    v_mfma_f32_16x16x32_bf16 v[32:35], v[124:127], v[152:155], v[32:35]
    ds_read_b128 v[108:111], v13 offset:16384
    v_mfma_f32_16x16x32_bf16 v[36:39], v[124:127], v[156:159], v[36:39]
    ds_read_b128 v[112:115], v13 offset:18432
    v_mfma_f32_16x16x32_bf16 v[40:43], v[128:131], v[136:139], v[40:43]
    ds_read_b128 v[116:119], v13 offset:20480
    v_mfma_f32_16x16x32_bf16 v[44:47], v[128:131], v[140:143], v[44:47]
    ds_read_b128 v[120:123], v13 offset:22528
    v_mfma_f32_16x16x32_bf16 v[48:51], v[128:131], v[144:147], v[48:51]
    ds_read_b64_tr_b16 v[92:93], v11 offset:24576
    v_mfma_f32_16x16x32_bf16 v[52:55], v[128:131], v[148:151], v[52:55]
    ds_read_b64_tr_b16 v[94:95], v11 offset:26112
    v_mfma_f32_16x16x32_bf16 v[56:59], v[128:131], v[152:155], v[56:59]
    ds_read_b64_tr_b16 v[96:97], v12 offset:24576
    v_mfma_f32_16x16x32_bf16 v[60:63], v[128:131], v[156:159], v[60:63]
    ds_read_b64_tr_b16 v[98:99], v12 offset:26112
    v_mfma_f32_16x16x32_bf16 v[64:67], v[132:135], v[136:139], v[64:67]
    v_mfma_f32_16x16x32_bf16 v[68:71], v[132:135], v[140:143], v[68:71]
    v_mfma_f32_16x16x32_bf16 v[72:75], v[132:135], v[144:147], v[72:75]
    v_mfma_f32_16x16x32_bf16 v[76:79], v[132:135], v[148:151], v[76:79]
    v_mfma_f32_16x16x32_bf16 v[80:83], v[132:135], v[152:155], v[80:83]
    v_mfma_f32_16x16x32_bf16 v[84:87], v[132:135], v[156:159], v[84:87]
    s_waitcnt lgkmcnt(0)
    s_barrier
    v_mfma_f32_16x16x32_bf16 v[16:19], v[88:91], v[100:103], v[16:19]
    ds_read_b64_tr_b16 v[124:125], v10 offset:36864
    v_mfma_f32_16x16x32_bf16 v[20:23], v[88:91], v[104:107], v[20:23]
    ds_read_b64_tr_b16 v[126:127], v10 offset:38400
    v_mfma_f32_16x16x32_bf16 v[24:27], v[88:91], v[108:111], v[24:27]
    ds_read_b128 v[136:139], v14 offset:12288
    v_mfma_f32_16x16x32_bf16 v[28:31], v[88:91], v[112:115], v[28:31]
    ds_read_b128 v[140:143], v14 offset:14336
    v_mfma_f32_16x16x32_bf16 v[32:35], v[88:91], v[116:119], v[32:35]
    ds_read_b128 v[144:147], v14 offset:16384
    v_mfma_f32_16x16x32_bf16 v[36:39], v[88:91], v[120:123], v[36:39]
    ds_read_b128 v[148:151], v14 offset:18432
    v_mfma_f32_16x16x32_bf16 v[40:43], v[92:95], v[100:103], v[40:43]
    ds_read_b128 v[152:155], v14 offset:20480
    v_mfma_f32_16x16x32_bf16 v[44:47], v[92:95], v[104:107], v[44:47]
    ds_read_b128 v[156:159], v14 offset:22528
    v_mfma_f32_16x16x32_bf16 v[48:51], v[92:95], v[108:111], v[48:51]
    ds_read_b64_tr_b16 v[128:129], v11 offset:36864
    v_mfma_f32_16x16x32_bf16 v[52:55], v[92:95], v[112:115], v[52:55]
    ds_read_b64_tr_b16 v[130:131], v11 offset:38400
    v_mfma_f32_16x16x32_bf16 v[56:59], v[92:95], v[116:119], v[56:59]
    ds_read_b64_tr_b16 v[132:133], v12 offset:36864
    v_mfma_f32_16x16x32_bf16 v[60:63], v[92:95], v[120:123], v[60:63]
    ds_read_b64_tr_b16 v[134:135], v12 offset:38400
    v_mfma_f32_16x16x32_bf16 v[64:67], v[96:99], v[100:103], v[64:67]
    v_mfma_f32_16x16x32_bf16 v[68:71], v[96:99], v[104:107], v[68:71]
    v_mfma_f32_16x16x32_bf16 v[72:75], v[96:99], v[108:111], v[72:75]
    v_mfma_f32_16x16x32_bf16 v[76:79], v[96:99], v[112:115], v[76:79]
    v_mfma_f32_16x16x32_bf16 v[80:83], v[96:99], v[116:119], v[80:83]
    v_mfma_f32_16x16x32_bf16 v[84:87], v[96:99], v[120:123], v[84:87]
    s_waitcnt lgkmcnt(0)
    s_barrier
    v_mfma_f32_16x16x32_bf16 v[16:19], v[124:127], v[136:139], v[16:19]
    ds_read_b64_tr_b16 v[88:89], v10 offset:0
    v_mfma_f32_16x16x32_bf16 v[20:23], v[124:127], v[140:143], v[20:23]
    ds_read_b64_tr_b16 v[90:91], v10 offset:1536
    v_mfma_f32_16x16x32_bf16 v[24:27], v[124:127], v[144:147], v[24:27]
    ds_read_b128 v[100:103], v13 offset:24576
    v_mfma_f32_16x16x32_bf16 v[28:31], v[124:127], v[148:151], v[28:31]
    ds_read_b128 v[104:107], v13 offset:26624
    v_mfma_f32_16x16x32_bf16 v[32:35], v[124:127], v[152:155], v[32:35]
    ds_read_b128 v[108:111], v13 offset:28672
    v_mfma_f32_16x16x32_bf16 v[36:39], v[124:127], v[156:159], v[36:39]
    ds_read_b128 v[112:115], v13 offset:30720
    v_mfma_f32_16x16x32_bf16 v[40:43], v[128:131], v[136:139], v[40:43]
    ds_read_b128 v[116:119], v13 offset:32768
    v_mfma_f32_16x16x32_bf16 v[44:47], v[128:131], v[140:143], v[44:47]
    ds_read_b128 v[120:123], v13 offset:34816
    v_mfma_f32_16x16x32_bf16 v[48:51], v[128:131], v[144:147], v[48:51]
    ds_read_b64_tr_b16 v[92:93], v11 offset:0
    v_mfma_f32_16x16x32_bf16 v[52:55], v[128:131], v[148:151], v[52:55]
    ds_read_b64_tr_b16 v[94:95], v11 offset:1536
    v_mfma_f32_16x16x32_bf16 v[56:59], v[128:131], v[152:155], v[56:59]
    ds_read_b64_tr_b16 v[96:97], v12 offset:0
    v_mfma_f32_16x16x32_bf16 v[60:63], v[128:131], v[156:159], v[60:63]
    ds_read_b64_tr_b16 v[98:99], v12 offset:1536
    v_mfma_f32_16x16x32_bf16 v[64:67], v[132:135], v[136:139], v[64:67]
    v_mfma_f32_16x16x32_bf16 v[68:71], v[132:135], v[140:143], v[68:71]
    v_mfma_f32_16x16x32_bf16 v[72:75], v[132:135], v[144:147], v[72:75]
    v_mfma_f32_16x16x32_bf16 v[76:79], v[132:135], v[148:151], v[76:79]
    v_mfma_f32_16x16x32_bf16 v[80:83], v[132:135], v[152:155], v[80:83]
    v_mfma_f32_16x16x32_bf16 v[84:87], v[132:135], v[156:159], v[84:87]
    s_waitcnt lgkmcnt(0)
    s_barrier
    v_mfma_f32_16x16x32_bf16 v[16:19], v[88:91], v[100:103], v[16:19]
    ds_read_b64_tr_b16 v[124:125], v10 offset:12288
    v_mfma_f32_16x16x32_bf16 v[20:23], v[88:91], v[104:107], v[20:23]
    ds_read_b64_tr_b16 v[126:127], v10 offset:13824
    v_mfma_f32_16x16x32_bf16 v[24:27], v[88:91], v[108:111], v[24:27]
    ds_read_b128 v[136:139], v14 offset:24576
    v_mfma_f32_16x16x32_bf16 v[28:31], v[88:91], v[112:115], v[28:31]
    ds_read_b128 v[140:143], v14 offset:26624
    v_mfma_f32_16x16x32_bf16 v[32:35], v[88:91], v[116:119], v[32:35]
    ds_read_b128 v[144:147], v14 offset:28672
    v_mfma_f32_16x16x32_bf16 v[36:39], v[88:91], v[120:123], v[36:39]
    ds_read_b128 v[148:151], v14 offset:30720
    v_mfma_f32_16x16x32_bf16 v[40:43], v[92:95], v[100:103], v[40:43]
    ds_read_b128 v[152:155], v14 offset:32768
    v_mfma_f32_16x16x32_bf16 v[44:47], v[92:95], v[104:107], v[44:47]
    ds_read_b128 v[156:159], v14 offset:34816
    v_mfma_f32_16x16x32_bf16 v[48:51], v[92:95], v[108:111], v[48:51]
    ds_read_b64_tr_b16 v[128:129], v11 offset:12288
    v_mfma_f32_16x16x32_bf16 v[52:55], v[92:95], v[112:115], v[52:55]
    ds_read_b64_tr_b16 v[130:131], v11 offset:13824
    v_mfma_f32_16x16x32_bf16 v[56:59], v[92:95], v[116:119], v[56:59]
    ds_read_b64_tr_b16 v[132:133], v12 offset:12288
    v_mfma_f32_16x16x32_bf16 v[60:63], v[92:95], v[120:123], v[60:63]
    ds_read_b64_tr_b16 v[134:135], v12 offset:13824
    v_mfma_f32_16x16x32_bf16 v[64:67], v[96:99], v[100:103], v[64:67]
    v_mfma_f32_16x16x32_bf16 v[68:71], v[96:99], v[104:107], v[68:71]
    v_mfma_f32_16x16x32_bf16 v[72:75], v[96:99], v[108:111], v[72:75]
    v_mfma_f32_16x16x32_bf16 v[76:79], v[96:99], v[112:115], v[76:79]
    v_mfma_f32_16x16x32_bf16 v[80:83], v[96:99], v[116:119], v[80:83]
    v_mfma_f32_16x16x32_bf16 v[84:87], v[96:99], v[120:123], v[84:87]
    s_waitcnt lgkmcnt(0)
    s_barrier
    v_mfma_f32_16x16x32_bf16 v[16:19], v[124:127], v[136:139], v[16:19]
    ds_read_b64_tr_b16 v[88:89], v10 offset:24576
    v_mfma_f32_16x16x32_bf16 v[20:23], v[124:127], v[140:143], v[20:23]
    ds_read_b64_tr_b16 v[90:91], v10 offset:26112
    v_mfma_f32_16x16x32_bf16 v[24:27], v[124:127], v[144:147], v[24:27]
    ds_read_b128 v[100:103], v13 offset:0
    v_mfma_f32_16x16x32_bf16 v[28:31], v[124:127], v[148:151], v[28:31]
    ds_read_b128 v[104:107], v13 offset:2048
    v_mfma_f32_16x16x32_bf16 v[32:35], v[124:127], v[152:155], v[32:35]
    ds_read_b128 v[108:111], v13 offset:4096
    v_mfma_f32_16x16x32_bf16 v[36:39], v[124:127], v[156:159], v[36:39]
    ds_read_b128 v[112:115], v13 offset:6144
    v_mfma_f32_16x16x32_bf16 v[40:43], v[128:131], v[136:139], v[40:43]
    ds_read_b128 v[116:119], v13 offset:8192
    v_mfma_f32_16x16x32_bf16 v[44:47], v[128:131], v[140:143], v[44:47]
    ds_read_b128 v[120:123], v13 offset:10240
    v_mfma_f32_16x16x32_bf16 v[48:51], v[128:131], v[144:147], v[48:51]
    ds_read_b64_tr_b16 v[92:93], v11 offset:24576
    v_mfma_f32_16x16x32_bf16 v[52:55], v[128:131], v[148:151], v[52:55]
    ds_read_b64_tr_b16 v[94:95], v11 offset:26112
    v_mfma_f32_16x16x32_bf16 v[56:59], v[128:131], v[152:155], v[56:59]
    ds_read_b64_tr_b16 v[96:97], v12 offset:24576
    v_mfma_f32_16x16x32_bf16 v[60:63], v[128:131], v[156:159], v[60:63]
    ds_read_b64_tr_b16 v[98:99], v12 offset:26112
    v_mfma_f32_16x16x32_bf16 v[64:67], v[132:135], v[136:139], v[64:67]
    v_mfma_f32_16x16x32_bf16 v[68:71], v[132:135], v[140:143], v[68:71]
    v_mfma_f32_16x16x32_bf16 v[72:75], v[132:135], v[144:147], v[72:75]
    v_mfma_f32_16x16x32_bf16 v[76:79], v[132:135], v[148:151], v[76:79]
    v_mfma_f32_16x16x32_bf16 v[80:83], v[132:135], v[152:155], v[80:83]
    v_mfma_f32_16x16x32_bf16 v[84:87], v[132:135], v[156:159], v[84:87]
    s_waitcnt lgkmcnt(0)
    s_barrier
    v_mfma_f32_16x16x32_bf16 v[16:19], v[88:91], v[100:103], v[16:19]
    ds_read_b64_tr_b16 v[124:125], v10 offset:36864
    v_mfma_f32_16x16x32_bf16 v[20:23], v[88:91], v[104:107], v[20:23]
    ds_read_b64_tr_b16 v[126:127], v10 offset:38400
    v_mfma_f32_16x16x32_bf16 v[24:27], v[88:91], v[108:111], v[24:27]
    ds_read_b128 v[136:139], v14 offset:0
    v_mfma_f32_16x16x32_bf16 v[28:31], v[88:91], v[112:115], v[28:31]
    ds_read_b128 v[140:143], v14 offset:2048
    v_mfma_f32_16x16x32_bf16 v[32:35], v[88:91], v[116:119], v[32:35]
    ds_read_b128 v[144:147], v14 offset:4096
    v_mfma_f32_16x16x32_bf16 v[36:39], v[88:91], v[120:123], v[36:39]
    ds_read_b128 v[148:151], v14 offset:6144
    v_mfma_f32_16x16x32_bf16 v[40:43], v[92:95], v[100:103], v[40:43]
    ds_read_b128 v[152:155], v14 offset:8192
    v_mfma_f32_16x16x32_bf16 v[44:47], v[92:95], v[104:107], v[44:47]
    ds_read_b128 v[156:159], v14 offset:10240
    v_mfma_f32_16x16x32_bf16 v[48:51], v[92:95], v[108:111], v[48:51]
    ds_read_b64_tr_b16 v[128:129], v11 offset:36864
    v_mfma_f32_16x16x32_bf16 v[52:55], v[92:95], v[112:115], v[52:55]
    ds_read_b64_tr_b16 v[130:131], v11 offset:38400
    v_mfma_f32_16x16x32_bf16 v[56:59], v[92:95], v[116:119], v[56:59]
    ds_read_b64_tr_b16 v[132:133], v12 offset:36864
    v_mfma_f32_16x16x32_bf16 v[60:63], v[92:95], v[120:123], v[60:63]
    ds_read_b64_tr_b16 v[134:135], v12 offset:38400
    v_mfma_f32_16x16x32_bf16 v[64:67], v[96:99], v[100:103], v[64:67]
    v_mfma_f32_16x16x32_bf16 v[68:71], v[96:99], v[104:107], v[68:71]
    v_mfma_f32_16x16x32_bf16 v[72:75], v[96:99], v[108:111], v[72:75]
    v_mfma_f32_16x16x32_bf16 v[76:79], v[96:99], v[112:115], v[76:79]
    v_mfma_f32_16x16x32_bf16 v[80:83], v[96:99], v[116:119], v[80:83]
    v_mfma_f32_16x16x32_bf16 v[84:87], v[96:99], v[120:123], v[84:87]
    s_waitcnt lgkmcnt(0)
    v_mfma_f32_16x16x32_bf16 v[16:19], v[124:127], v[136:139], v[16:19]
    v_mfma_f32_16x16x32_bf16 v[20:23], v[124:127], v[140:143], v[20:23]
    v_mfma_f32_16x16x32_bf16 v[24:27], v[124:127], v[144:147], v[24:27]
    v_mfma_f32_16x16x32_bf16 v[28:31], v[124:127], v[148:151], v[28:31]
    v_mfma_f32_16x16x32_bf16 v[32:35], v[124:127], v[152:155], v[32:35]
    v_mfma_f32_16x16x32_bf16 v[36:39], v[124:127], v[156:159], v[36:39]
    v_mfma_f32_16x16x32_bf16 v[40:43], v[128:131], v[136:139], v[40:43]
    s_nop 1
    v_cvt_pk_bf16_f32 v88, v16, v17
    v_cvt_pk_bf16_f32 v89, v18, v19
    v_mfma_f32_16x16x32_bf16 v[44:47], v[128:131], v[140:143], v[44:47]
    ds_write_b64 v15, v[88:89] offset:0
    v_cvt_pk_bf16_f32 v90, v20, v21
    v_mfma_f32_16x16x32_bf16 v[48:51], v[128:131], v[144:147], v[48:51]
    v_cvt_pk_bf16_f32 v91, v22, v23
    ds_write_b64 v15, v[90:91] offset:256
    v_mfma_f32_16x16x32_bf16 v[52:55], v[128:131], v[148:151], v[52:55]
    v_cvt_pk_bf16_f32 v92, v24, v25
    v_cvt_pk_bf16_f32 v93, v26, v27
    v_mfma_f32_16x16x32_bf16 v[56:59], v[128:131], v[152:155], v[56:59]
    ds_write_b64 v15, v[92:93] offset:12288
    v_cvt_pk_bf16_f32 v94, v28, v29
    v_mfma_f32_16x16x32_bf16 v[60:63], v[128:131], v[156:159], v[60:63]
    v_cvt_pk_bf16_f32 v95, v30, v31
    ds_write_b64 v15, v[94:95] offset:12544
    v_mfma_f32_16x16x32_bf16 v[64:67], v[132:135], v[136:139], v[64:67]
    v_cvt_pk_bf16_f32 v96, v32, v33
    v_cvt_pk_bf16_f32 v97, v34, v35
    v_mfma_f32_16x16x32_bf16 v[68:71], v[132:135], v[140:143], v[68:71]
    ds_write_b64 v15, v[96:97] offset:24576
    v_cvt_pk_bf16_f32 v98, v36, v37
    v_mfma_f32_16x16x32_bf16 v[72:75], v[132:135], v[144:147], v[72:75]
    v_cvt_pk_bf16_f32 v99, v38, v39
    ds_write_b64 v15, v[98:99] offset:24832
    v_mfma_f32_16x16x32_bf16 v[76:79], v[132:135], v[148:151], v[76:79]
    v_cvt_pk_bf16_f32 v100, v40, v41
    v_cvt_pk_bf16_f32 v101, v42, v43
    v_mfma_f32_16x16x32_bf16 v[80:83], v[132:135], v[152:155], v[80:83]
    ds_write_b64 v15, v[100:101] offset:1024
    v_cvt_pk_bf16_f32 v102, v44, v45
    v_mfma_f32_16x16x32_bf16 v[84:87], v[132:135], v[156:159], v[84:87]
    v_cvt_pk_bf16_f32 v103, v46, v47
    ds_write_b64 v15, v[102:103] offset:1280
    v_cvt_pk_bf16_f32 v88, v48, v49
    v_cvt_pk_bf16_f32 v89, v50, v51
    ds_write_b64 v15, v[88:89] offset:13312
    v_cvt_pk_bf16_f32 v90, v52, v53
    v_cvt_pk_bf16_f32 v91, v54, v55
    ds_write_b64 v15, v[90:91] offset:13568
    v_cvt_pk_bf16_f32 v92, v56, v57
    v_cvt_pk_bf16_f32 v93, v58, v59
    ds_write_b64 v15, v[92:93] offset:25600
    v_cvt_pk_bf16_f32 v94, v60, v61
    v_cvt_pk_bf16_f32 v95, v62, v63
    ds_write_b64 v15, v[94:95] offset:25856
    v_cvt_pk_bf16_f32 v96, v64, v65
    v_cvt_pk_bf16_f32 v97, v66, v67
    ds_write_b64 v15, v[96:97] offset:2048
    v_cvt_pk_bf16_f32 v98, v68, v69
    v_cvt_pk_bf16_f32 v99, v70, v71
    ds_write_b64 v15, v[98:99] offset:2304
    v_cvt_pk_bf16_f32 v100, v72, v73
    v_cvt_pk_bf16_f32 v101, v74, v75
    ds_write_b64 v15, v[100:101] offset:14336
    v_cvt_pk_bf16_f32 v102, v76, v77
    v_cvt_pk_bf16_f32 v103, v78, v79
    ds_write_b64 v15, v[102:103] offset:14592
    v_cvt_pk_bf16_f32 v88, v80, v81
    v_cvt_pk_bf16_f32 v89, v82, v83
    ds_write_b64 v15, v[88:89] offset:26624
    v_cvt_pk_bf16_f32 v90, v84, v85
    v_cvt_pk_bf16_f32 v91, v86, v87
    ds_write_b64 v15, v[90:91] offset:26880
    s_waitcnt lgkmcnt(0)
    s_barrier
    s_cmp_lt_u32 s20, 3
    s_cbranch_scc1 L_phaseB
    s_barrier
    s_barrier
    s_branch L_computeC
L_phaseB:
    s_mul_i32 s56, s20, 12288
    v_add_u32 v10, s56, v240
    ds_read_b128 v[72:75], v10 offset:0
    ds_read_b128 v[120:123], v232 offset:0
    v_xor_b32 v11, 32, v232
    v_xor_b32 v12, 64, v232
    v_xor_b32 v13, 96, v232
    ds_read_b128 v[76:79], v10 offset:1024
    ds_read_b128 v[124:127], v11 offset:0
    ds_read_b128 v[80:83], v10 offset:2048
    ds_read_b128 v[128:131], v12 offset:0
    ds_read_b128 v[132:135], v13 offset:0
    v_xor_b32 v14, 64, v233
    s_mov_b32 s88, 0x3dd53b95
    s_mov_b32 s89, 0x3dd53b95
    s_waitcnt lgkmcnt(3)
    v_mfma_f32_32x32x16_bf16 v[16:31], v[120:123], v[72:75], 0
    ds_read_b128 v[120:123], v232 offset:128
    ds_read_b128 v[84:87], v10 offset:3072
    v_mfma_f32_32x32x16_bf16 v[16:31], v[124:127], v[76:79], v[16:31]
    ds_read_b128 v[124:127], v11 offset:128
    ds_read_b128 v[88:91], v10 offset:4096
    s_waitcnt lgkmcnt(2)
    v_mfma_f32_32x32x16_bf16 v[16:31], v[128:131], v[80:83], v[16:31]
    ds_read_b128 v[128:131], v12 offset:128
    ds_read_b128 v[92:95], v10 offset:5120
    v_mfma_f32_32x32x16_bf16 v[16:31], v[132:135], v[84:87], v[16:31]
    ds_read_b128 v[132:135], v13 offset:128
    ds_read_b128 v[96:99], v10 offset:6144
    s_waitcnt lgkmcnt(2)
    v_mfma_f32_32x32x16_bf16 v[16:31], v[120:123], v[88:91], v[16:31]
    ds_read_b128 v[120:123], v232 offset:256
    ds_read_b128 v[100:103], v10 offset:7168
    v_mfma_f32_32x32x16_bf16 v[16:31], v[124:127], v[92:95], v[16:31]
    ds_read_b128 v[124:127], v11 offset:256
    ds_read_b128 v[104:107], v10 offset:8192
    s_waitcnt lgkmcnt(2)
    v_mfma_f32_32x32x16_bf16 v[16:31], v[128:131], v[96:99], v[16:31]
    ds_read_b128 v[128:131], v12 offset:256
    ds_read_b128 v[108:111], v10 offset:9216
    v_mfma_f32_32x32x16_bf16 v[16:31], v[132:135], v[100:103], v[16:31]
    ds_read_b128 v[132:135], v13 offset:256
    ds_read_b128 v[112:115], v10 offset:10240
    s_waitcnt lgkmcnt(2)
    v_mfma_f32_32x32x16_bf16 v[16:31], v[120:123], v[104:107], v[16:31]
    ds_read_b128 v[120:123], v232 offset:12288
    ds_read_b128 v[116:119], v10 offset:11264
    v_mfma_f32_32x32x16_bf16 v[16:31], v[124:127], v[108:111], v[16:31]
    ds_read_b128 v[124:127], v11 offset:12288
    s_waitcnt lgkmcnt(1)
    v_mfma_f32_32x32x16_bf16 v[16:31], v[128:131], v[112:115], v[16:31]
    ds_read_b128 v[128:131], v12 offset:12288
    v_mfma_f32_32x32x16_bf16 v[16:31], v[132:135], v[116:119], v[16:31]
    ds_read_b128 v[132:135], v13 offset:12288
    s_waitcnt lgkmcnt(2)
    v_mfma_f32_32x32x16_bf16 v[32:47], v[120:123], v[72:75], 0
    ds_read_b128 v[120:123], v232 offset:12416
    v_mfma_f32_32x32x16_bf16 v[32:47], v[124:127], v[76:79], v[32:47]
    ds_read_b128 v[124:127], v11 offset:12416
    s_waitcnt lgkmcnt(2)
    v_mfma_f32_32x32x16_bf16 v[32:47], v[128:131], v[80:83], v[32:47]
    ds_read_b128 v[128:131], v12 offset:12416
    s_nop 2
    v_max3_f32 v2, v16, v17, v18
    v_max3_f32 v3, v19, v20, v21
    v_max3_f32 v2, v2, v22, v23
    v_max3_f32 v3, v3, v24, v25
    v_max3_f32 v2, v2, v26, v27
    v_mfma_f32_32x32x16_bf16 v[32:47], v[132:135], v[84:87], v[32:47]
    ds_read_b128 v[132:135], v13 offset:12416
    v_max3_f32 v3, v3, v28, v29
    v_max3_f32 v2, v2, v30, v31
    v_max_f32 v2, v2, v3
    v_mov_b32 v3, v2
    s_nop 1
    s_waitcnt lgkmcnt(2)
    v_mfma_f32_32x32x16_bf16 v[32:47], v[120:123], v[88:91], v[32:47]
    ds_read_b128 v[120:123], v232 offset:12544
    v_permlane32_swap_b32 v2, v3
    v_max_f32 v2, v2, v3
    v_mul_f32 v4, 0xbdd53b95, v2
    v_fmamk_f32 v16, v16, 0x3dd53b95, v4
    v_fmamk_f32 v17, v17, 0x3dd53b95, v4
    v_mfma_f32_32x32x16_bf16 v[32:47], v[124:127], v[92:95], v[32:47]
    ds_read_b128 v[124:127], v11 offset:12544
    v_exp_f32 v16, v16
    v_fmamk_f32 v18, v18, 0x3dd53b95, v4
    v_exp_f32 v17, v17
    v_fmamk_f32 v19, v19, 0x3dd53b95, v4
    v_exp_f32 v18, v18
    s_waitcnt lgkmcnt(2)
    v_mfma_f32_32x32x16_bf16 v[32:47], v[128:131], v[96:99], v[32:47]
    ds_read_b128 v[128:131], v12 offset:12544
    v_fmamk_f32 v20, v20, 0x3dd53b95, v4
    v_exp_f32 v19, v19
    v_add_f32 v7, v16, v17
    v_fmamk_f32 v21, v21, 0x3dd53b95, v4
    v_exp_f32 v20, v20
    v_mfma_f32_32x32x16_bf16 v[32:47], v[132:135], v[100:103], v[32:47]
    ds_read_b128 v[132:135], v13 offset:12544
    v_fmamk_f32 v22, v22, 0x3dd53b95, v4
    v_exp_f32 v21, v21
    v_add_f32 v8, v18, v19
    v_fmamk_f32 v23, v23, 0x3dd53b95, v4
    v_exp_f32 v22, v22
    s_waitcnt lgkmcnt(2)
    v_mfma_f32_32x32x16_bf16 v[32:47], v[120:123], v[104:107], v[32:47]
    ds_read_b128 v[120:123], v232 offset:24576
    v_add_f32 v7, v7, v20
    v_fmamk_f32 v24, v24, 0x3dd53b95, v4
    v_exp_f32 v23, v23
    v_add_f32 v8, v8, v21
    v_fmamk_f32 v25, v25, 0x3dd53b95, v4
    v_mfma_f32_32x32x16_bf16 v[32:47], v[124:127], v[108:111], v[32:47]
    ds_read_b128 v[124:127], v11 offset:24576
    v_exp_f32 v24, v24
    v_add_f32 v7, v7, v22
    v_fmamk_f32 v26, v26, 0x3dd53b95, v4
    v_exp_f32 v25, v25
    v_add_f32 v8, v8, v23
    s_waitcnt lgkmcnt(2)
    v_mfma_f32_32x32x16_bf16 v[32:47], v[128:131], v[112:115], v[32:47]
    ds_read_b128 v[128:131], v12 offset:24576
    v_fmamk_f32 v27, v27, 0x3dd53b95, v4
    v_exp_f32 v26, v26
    v_add_f32 v7, v7, v24
    v_fmamk_f32 v28, v28, 0x3dd53b95, v4
    v_exp_f32 v27, v27
    v_mfma_f32_32x32x16_bf16 v[32:47], v[132:135], v[116:119], v[32:47]
    ds_read_b128 v[132:135], v13 offset:24576
    v_add_f32 v8, v8, v25
    v_fmamk_f32 v29, v29, 0x3dd53b95, v4
    v_exp_f32 v28, v28
    v_add_f32 v7, v7, v26
    v_fmamk_f32 v30, v30, 0x3dd53b95, v4
    s_waitcnt lgkmcnt(2)
    v_mfma_f32_32x32x16_bf16 v[48:63], v[120:123], v[72:75], 0
    ds_read_b128 v[120:123], v232 offset:24704
    v_exp_f32 v29, v29
    v_add_f32 v8, v8, v27
    v_fmamk_f32 v31, v31, 0x3dd53b95, v4
    v_exp_f32 v30, v30
    v_add_f32 v7, v7, v28
    v_mfma_f32_32x32x16_bf16 v[48:63], v[124:127], v[76:79], v[48:63]
    ds_read_b128 v[124:127], v11 offset:24704
    v_exp_f32 v31, v31
    v_add_f32 v8, v8, v29
    v_add_f32 v7, v7, v30
    v_add_f32 v8, v8, v31
    s_waitcnt lgkmcnt(2)
    v_mfma_f32_32x32x16_bf16 v[48:63], v[128:131], v[80:83], v[48:63]
    ds_read_b128 v[128:131], v12 offset:24704
    v_max3_f32 v3, v32, v33, v34
    v_max3_f32 v2, v2, v35, v36
    v_max3_f32 v3, v3, v37, v38
    v_max3_f32 v2, v2, v39, v40
    v_max3_f32 v3, v3, v41, v42
    v_mfma_f32_32x32x16_bf16 v[48:63], v[132:135], v[84:87], v[48:63]
    ds_read_b128 v[132:135], v13 offset:24704
    v_max3_f32 v2, v2, v43, v44
    v_max3_f32 v3, v3, v45, v46
    v_max3_f32 v2, v2, v3, v47
    v_mov_b32 v3, v2
    s_nop 1
    s_waitcnt lgkmcnt(2)
    v_mfma_f32_32x32x16_bf16 v[48:63], v[120:123], v[88:91], v[48:63]
    ds_read_b128 v[120:123], v232 offset:24832
    v_permlane32_swap_b32 v2, v3
    v_max_f32 v2, v2, v3
    v_mul_f32 v5, 0xbdd53b95, v2
    v_fmamk_f32 v32, v32, 0x3dd53b95, v5
    v_fmamk_f32 v33, v33, 0x3dd53b95, v5
    v_mfma_f32_32x32x16_bf16 v[48:63], v[124:127], v[92:95], v[48:63]
    ds_read_b128 v[124:127], v11 offset:24832
    v_exp_f32 v32, v32
    v_fmamk_f32 v34, v34, 0x3dd53b95, v5
    v_exp_f32 v33, v33
    v_fmamk_f32 v35, v35, 0x3dd53b95, v5
    v_exp_f32 v34, v34
    s_waitcnt lgkmcnt(2)
    v_mfma_f32_32x32x16_bf16 v[48:63], v[128:131], v[96:99], v[48:63]
    ds_read_b128 v[128:131], v12 offset:24832
    v_fmamk_f32 v36, v36, 0x3dd53b95, v5
    v_exp_f32 v35, v35
    v_add_f32 v9, v32, v33
    v_fmamk_f32 v37, v37, 0x3dd53b95, v5
    v_exp_f32 v36, v36
    v_mfma_f32_32x32x16_bf16 v[48:63], v[132:135], v[100:103], v[48:63]
    ds_read_b128 v[132:135], v13 offset:24832
    v_fmamk_f32 v38, v38, 0x3dd53b95, v5
    v_exp_f32 v37, v37
    v_add_f32 v15, v34, v35
    v_fmamk_f32 v39, v39, 0x3dd53b95, v5
    v_exp_f32 v38, v38
    s_waitcnt lgkmcnt(2)
    v_mfma_f32_32x32x16_bf16 v[48:63], v[120:123], v[104:107], v[48:63]
    v_add_f32 v9, v9, v36
    v_fmamk_f32 v40, v40, 0x3dd53b95, v5
    v_exp_f32 v39, v39
    v_add_f32 v15, v15, v37
    v_fmamk_f32 v41, v41, 0x3dd53b95, v5
    v_mfma_f32_32x32x16_bf16 v[48:63], v[124:127], v[108:111], v[48:63]
    v_exp_f32 v40, v40
    v_add_f32 v9, v9, v38
    v_fmamk_f32 v42, v42, 0x3dd53b95, v5
    v_exp_f32 v41, v41
    v_add_f32 v15, v15, v39
    s_waitcnt lgkmcnt(0)
    v_mfma_f32_32x32x16_bf16 v[48:63], v[128:131], v[112:115], v[48:63]
    v_fmamk_f32 v43, v43, 0x3dd53b95, v5
    v_exp_f32 v42, v42
    v_add_f32 v9, v9, v40
    v_fmamk_f32 v44, v44, 0x3dd53b95, v5
    v_exp_f32 v43, v43
    v_mfma_f32_32x32x16_bf16 v[48:63], v[132:135], v[116:119], v[48:63]
    v_add_f32 v15, v15, v41
    v_fmamk_f32 v45, v45, 0x3dd53b95, v5
    v_exp_f32 v44, v44
    v_add_f32 v9, v9, v42
    v_fmamk_f32 v46, v46, 0x3dd53b95, v5
    s_barrier
    ds_read_b64_tr_b16 v[88:89], v233 offset:0
    ds_read_b64_tr_b16 v[90:91], v233 offset:3072
    ds_read_b64_tr_b16 v[92:93], v233 offset:6144
    ds_read_b64_tr_b16 v[94:95], v233 offset:9216
    ds_read_b64_tr_b16 v[96:97], v233 offset:12288
    ds_read_b64_tr_b16 v[98:99], v233 offset:15360
    ds_read_b64_tr_b16 v[100:101], v233 offset:18432
    ds_read_b64_tr_b16 v[102:103], v233 offset:21504
    ds_read_b64_tr_b16 v[104:105], v233 offset:24576
    ds_read_b64_tr_b16 v[106:107], v233 offset:27648
    ds_read_b64_tr_b16 v[108:109], v233 offset:30720
    ds_read_b64_tr_b16 v[110:111], v233 offset:33792
    v_mov_b32 v1, 159744
    ds_read_b32 v1, v1
    v_exp_f32 v45, v45
    v_add_f32 v15, v15, v43
    v_fmamk_f32 v47, v47, 0x3dd53b95, v5
    v_exp_f32 v46, v46
    v_add_f32 v9, v9, v44
    v_exp_f32 v47, v47
    v_add_f32 v15, v15, v45
    v_add_f32 v9, v9, v46
    v_add_f32 v15, v15, v47
    v_max3_f32 v3, v48, v49, v50
    v_max3_f32 v2, v2, v51, v52
    v_max3_f32 v3, v3, v53, v54
    v_max3_f32 v2, v2, v55, v56
    v_max3_f32 v3, v3, v57, v58
    v_max3_f32 v2, v2, v59, v60
    v_max3_f32 v3, v3, v61, v62
    v_max3_f32 v2, v2, v3, v63
    v_mov_b32 v3, v2
    s_nop 1
    v_permlane32_swap_b32 v2, v3
    v_max_f32 v2, v2, v3
    v_mul_f32 v6, 0xbdd53b95, v2
    v_sub_f32 v4, v6, v4
    v_sub_f32 v5, v6, v5
    v_pk_fma_f32 v[48:49], v[48:49], s[88:89], v[6:7] op_sel_hi:[1,1,0]
    v_pk_fma_f32 v[50:51], v[50:51], s[88:89], v[6:7] op_sel_hi:[1,1,0]
    v_pk_fma_f32 v[52:53], v[52:53], s[88:89], v[6:7] op_sel_hi:[1,1,0]
    v_pk_fma_f32 v[54:55], v[54:55], s[88:89], v[6:7] op_sel_hi:[1,1,0]
    v_pk_fma_f32 v[56:57], v[56:57], s[88:89], v[6:7] op_sel_hi:[1,1,0]
    v_pk_fma_f32 v[58:59], v[58:59], s[88:89], v[6:7] op_sel_hi:[1,1,0]
    v_pk_fma_f32 v[60:61], v[60:61], s[88:89], v[6:7] op_sel_hi:[1,1,0]
    v_pk_fma_f32 v[62:63], v[62:63], s[88:89], v[6:7] op_sel_hi:[1,1,0]
    v_exp_f32 v4, v4
    v_exp_f32 v5, v5
    v_add_f32 v7, v7, v8
    v_add_f32 v9, v9, v15
    v_exp_f32 v48, v48
    v_exp_f32 v49, v49
    v_exp_f32 v50, v50
    v_exp_f32 v51, v51
    v_exp_f32 v52, v52
    v_exp_f32 v53, v53
    v_exp_f32 v54, v54
    v_exp_f32 v55, v55
    v_exp_f32 v56, v56
    v_exp_f32 v57, v57
    v_exp_f32 v58, v58
    v_exp_f32 v59, v59
    v_exp_f32 v60, v60
    v_exp_f32 v61, v61
    v_exp_f32 v62, v62
    v_exp_f32 v63, v63
    v_mul_f32 v7, v7, v4
    v_fmac_f32 v7, v9, v5
    v_pk_add_f32 v[10:11], v[48:49], v[50:51]
    v_pk_add_f32 v[2:3], v[52:53], v[54:55]
    v_pk_add_f32 v[10:11], v[10:11], v[56:57]
    v_pk_add_f32 v[2:3], v[2:3], v[58:59]
    v_pk_add_f32 v[10:11], v[10:11], v[60:61]
    v_pk_add_f32 v[2:3], v[2:3], v[62:63]
    v_pk_add_f32 v[2:3], v[2:3], v[10:11]
    v_add_f32 v2, v2, v3
    v_add_f32 v2, v2, v7
    v_mov_b32 v3, v2
    s_nop 1
    v_permlane32_swap_b32 v2, v3
    v_add_f32 v2, v2, v3
    v_rcp_f32 v6, v2
    s_waitcnt lgkmcnt(0)
    v_readfirstlane_b32 s26, v1
    v_mul_f32 v4, v4, v6
    v_mul_f32 v5, v5, v6
    s_cmp_lg_u32 s26, 0
    s_cselect_b64 vcc, -1, 0
    v_pk_mul_f32 v[16:17], v[16:17], v[4:5] op_sel:[0,0] op_sel_hi:[1,0]
    v_pk_mul_f32 v[18:19], v[18:19], v[4:5] op_sel:[0,0] op_sel_hi:[1,0]
    v_pk_mul_f32 v[20:21], v[20:21], v[4:5] op_sel:[0,0] op_sel_hi:[1,0]
    v_pk_mul_f32 v[22:23], v[22:23], v[4:5] op_sel:[0,0] op_sel_hi:[1,0]
    v_cvt_pk_bf16_f32 v64, v16, v17
    v_cvt_pk_bf16_f32 v65, v18, v19
    v_cvt_pk_bf16_f32 v66, v20, v21
    v_cvt_pk_bf16_f32 v67, v22, v23
    v_pk_mul_f32 v[24:25], v[24:25], v[4:5] op_sel:[0,0] op_sel_hi:[1,0]
    v_pk_mul_f32 v[26:27], v[26:27], v[4:5] op_sel:[0,0] op_sel_hi:[1,0]
    v_pk_mul_f32 v[28:29], v[28:29], v[4:5] op_sel:[0,0] op_sel_hi:[1,0]
    v_pk_mul_f32 v[30:31], v[30:31], v[4:5] op_sel:[0,0] op_sel_hi:[1,0]
    v_cvt_pk_bf16_f32 v68, v24, v25
    v_cvt_pk_bf16_f32 v69, v26, v27
    v_cvt_pk_bf16_f32 v70, v28, v29
    v_cvt_pk_bf16_f32 v71, v30, v31
    v_pk_mul_f32 v[32:33], v[32:33], v[4:5] op_sel:[0,1] op_sel_hi:[1,1]
    v_pk_mul_f32 v[34:35], v[34:35], v[4:5] op_sel:[0,1] op_sel_hi:[1,1]
    v_pk_mul_f32 v[36:37], v[36:37], v[4:5] op_sel:[0,1] op_sel_hi:[1,1]
    v_pk_mul_f32 v[38:39], v[38:39], v[4:5] op_sel:[0,1] op_sel_hi:[1,1]
    v_cvt_pk_bf16_f32 v72, v32, v33
    v_cvt_pk_bf16_f32 v73, v34, v35
    v_cvt_pk_bf16_f32 v74, v36, v37
    v_cvt_pk_bf16_f32 v75, v38, v39
    v_pk_mul_f32 v[40:41], v[40:41], v[4:5] op_sel:[0,1] op_sel_hi:[1,1]
    v_pk_mul_f32 v[42:43], v[42:43], v[4:5] op_sel:[0,1] op_sel_hi:[1,1]
    v_pk_mul_f32 v[44:45], v[44:45], v[4:5] op_sel:[0,1] op_sel_hi:[1,1]
    v_pk_mul_f32 v[46:47], v[46:47], v[4:5] op_sel:[0,1] op_sel_hi:[1,1]
    v_cvt_pk_bf16_f32 v76, v40, v41
    v_cvt_pk_bf16_f32 v77, v42, v43
    v_cvt_pk_bf16_f32 v78, v44, v45
    v_cvt_pk_bf16_f32 v79, v46, v47
    v_pk_mul_f32 v[48:49], v[48:49], v[6:7] op_sel:[0,0] op_sel_hi:[1,0]
    v_pk_mul_f32 v[50:51], v[50:51], v[6:7] op_sel:[0,0] op_sel_hi:[1,0]
    v_pk_mul_f32 v[52:53], v[52:53], v[6:7] op_sel:[0,0] op_sel_hi:[1,0]
    v_pk_mul_f32 v[54:55], v[54:55], v[6:7] op_sel:[0,0] op_sel_hi:[1,0]
    v_cvt_pk_bf16_f32 v80, v48, v49
    v_cvt_pk_bf16_f32 v81, v50, v51
    v_cvt_pk_bf16_f32 v82, v52, v53
    v_cvt_pk_bf16_f32 v83, v54, v55
    v_pk_mul_f32 v[56:57], v[56:57], v[6:7] op_sel:[0,0] op_sel_hi:[1,0]
    v_pk_mul_f32 v[58:59], v[58:59], v[6:7] op_sel:[0,0] op_sel_hi:[1,0]
    v_pk_mul_f32 v[60:61], v[60:61], v[6:7] op_sel:[0,0] op_sel_hi:[1,0]
    v_pk_mul_f32 v[62:63], v[62:63], v[6:7] op_sel:[0,0] op_sel_hi:[1,0]
    v_cvt_pk_bf16_f32 v84, v56, v57
    v_cvt_pk_bf16_f32 v85, v58, v59
    v_cvt_pk_bf16_f32 v86, v60, v61
    v_cvt_pk_bf16_f32 v87, v62, v63
    v_mfma_f32_32x32x16_bf16 v[136:151], v[88:91], v[64:67], 0
    ds_read_b64_tr_b16 v[112:113], v14 offset:0
    ds_read_b64_tr_b16 v[114:115], v14 offset:3072
    v_mfma_f32_32x32x16_bf16 v[136:151], v[92:95], v[68:71], v[136:151]
    ds_read_b64_tr_b16 v[116:117], v14 offset:6144
    ds_read_b64_tr_b16 v[118:119], v14 offset:9216
    v_mfma_f32_32x32x16_bf16 v[136:151], v[96:99], v[72:75], v[136:151]
    ds_read_b64_tr_b16 v[120:121], v14 offset:12288
    ds_read_b64_tr_b16 v[122:123], v14 offset:15360
    v_mfma_f32_32x32x16_bf16 v[136:151], v[100:103], v[76:79], v[136:151]
    ds_read_b64_tr_b16 v[124:125], v14 offset:18432
    ds_read_b64_tr_b16 v[126:127], v14 offset:21504
    v_mfma_f32_32x32x16_bf16 v[136:151], v[104:107], v[80:83], v[136:151]
    ds_read_b64_tr_b16 v[128:129], v14 offset:24576
    ds_read_b64_tr_b16 v[130:131], v14 offset:27648
    v_mfma_f32_32x32x16_bf16 v[136:151], v[108:111], v[84:87], v[136:151]
    ds_read_b64_tr_b16 v[132:133], v14 offset:30720
    ds_read_b64_tr_b16 v[134:135], v14 offset:33792
    s_waitcnt lgkmcnt(8)
    v_mfma_f32_32x32x16_bf16 v[152:167], v[112:115], v[64:67], 0
    ds_read_b64_tr_b16 v[88:89], v233 offset:128
    ds_read_b64_tr_b16 v[90:91], v233 offset:3200
    v_mfma_f32_32x32x16_bf16 v[152:167], v[116:119], v[68:71], v[152:167]
    ds_read_b64_tr_b16 v[92:93], v233 offset:6272
    ds_read_b64_tr_b16 v[94:95], v233 offset:9344
    s_waitcnt lgkmcnt(8)
    v_mfma_f32_32x32x16_bf16 v[152:167], v[120:123], v[72:75], v[152:167]
    ds_read_b64_tr_b16 v[96:97], v233 offset:12416
    ds_read_b64_tr_b16 v[98:99], v233 offset:15488
    v_mfma_f32_32x32x16_bf16 v[152:167], v[124:127], v[76:79], v[152:167]
    ds_read_b64_tr_b16 v[100:101], v233 offset:18560
    ds_read_b64_tr_b16 v[102:103], v233 offset:21632
    v_cvt_pk_bf16_f32 v184, v136, v137
    v_cvt_pk_bf16_f32 v185, v138, v139
    s_waitcnt lgkmcnt(8)
    v_mfma_f32_32x32x16_bf16 v[152:167], v[128:131], v[80:83], v[152:167]
    ds_read_b64_tr_b16 v[104:105], v233 offset:24704
    ds_read_b64_tr_b16 v[106:107], v233 offset:27776
    v_cvt_pk_bf16_f32 v186, v140, v141
    v_cvt_pk_bf16_f32 v187, v142, v143
    v_mfma_f32_32x32x16_bf16 v[152:167], v[132:135], v[84:87], v[152:167]
    ds_read_b64_tr_b16 v[108:109], v233 offset:30848
    ds_read_b64_tr_b16 v[110:111], v233 offset:33920
    ds_write_b128 v234, v[184:187] offset:0
    s_add_u32 s56, s62, 0
    buffer_store_dwordx4 v[184:187], v234, s[44:47], s56 offen sc0 sc1
    s_waitcnt lgkmcnt(9)
    v_mfma_f32_32x32x16_bf16 v[168:183], v[88:91], v[64:67], 0
    ds_read_b64_tr_b16 v[112:113], v14 offset:128
    ds_read_b64_tr_b16 v[114:115], v14 offset:3200
    v_cvt_pk_bf16_f32 v188, v144, v145
    v_cvt_pk_bf16_f32 v189, v146, v147
    v_mfma_f32_32x32x16_bf16 v[168:183], v[92:95], v[68:71], v[168:183]
    ds_read_b64_tr_b16 v[116:117], v14 offset:6272
    ds_read_b64_tr_b16 v[118:119], v14 offset:9344
    v_cvt_pk_bf16_f32 v190, v148, v149
    v_cvt_pk_bf16_f32 v191, v150, v151
    s_waitcnt lgkmcnt(9)
    v_mfma_f32_32x32x16_bf16 v[168:183], v[96:99], v[72:75], v[168:183]
    ds_read_b64_tr_b16 v[120:121], v14 offset:12416
    ds_read_b64_tr_b16 v[122:123], v14 offset:15488
    ds_write_b128 v234, v[188:191] offset:512
    s_add_u32 s56, s62, 512
    buffer_store_dwordx4 v[188:191], v234, s[44:47], s56 offen sc0 sc1
    v_mfma_f32_32x32x16_bf16 v[168:183], v[100:103], v[76:79], v[168:183]
    ds_read_b64_tr_b16 v[124:125], v14 offset:18560
    ds_read_b64_tr_b16 v[126:127], v14 offset:21632
    v_cvt_pk_bf16_f32 v192, v152, v153
    v_cvt_pk_bf16_f32 v193, v154, v155
    s_waitcnt lgkmcnt(10)
    v_mfma_f32_32x32x16_bf16 v[168:183], v[104:107], v[80:83], v[168:183]
    ds_read_b64_tr_b16 v[128:129], v14 offset:24704
    ds_read_b64_tr_b16 v[130:131], v14 offset:27776
    v_cvt_pk_bf16_f32 v194, v156, v157
    v_cvt_pk_bf16_f32 v195, v158, v159
    v_mfma_f32_32x32x16_bf16 v[168:183], v[108:111], v[84:87], v[168:183]
    ds_read_b64_tr_b16 v[132:133], v14 offset:30848
    ds_read_b64_tr_b16 v[134:135], v14 offset:33920
    ds_write_b128 v234, v[192:195] offset:6144
    s_add_u32 s56, s62, 6144
    buffer_store_dwordx4 v[192:195], v234, s[44:47], s56 offen sc0 sc1
    s_waitcnt lgkmcnt(10)
    v_mfma_f32_32x32x16_bf16 v[136:151], v[112:115], v[64:67], 0
    ds_read_b64_tr_b16 v[88:89], v233 offset:256
    ds_read_b64_tr_b16 v[90:91], v233 offset:3328
    v_cvt_pk_bf16_f32 v196, v160, v161
    v_cvt_pk_bf16_f32 v197, v162, v163
    v_mfma_f32_32x32x16_bf16 v[136:151], v[116:119], v[68:71], v[136:151]
    ds_read_b64_tr_b16 v[92:93], v233 offset:6400
    ds_read_b64_tr_b16 v[94:95], v233 offset:9472
    v_cvt_pk_bf16_f32 v198, v164, v165
    v_cvt_pk_bf16_f32 v199, v166, v167
    s_waitcnt lgkmcnt(9)
    v_mfma_f32_32x32x16_bf16 v[136:151], v[120:123], v[72:75], v[136:151]
    ds_read_b64_tr_b16 v[96:97], v233 offset:12544
    ds_read_b64_tr_b16 v[98:99], v233 offset:15616
    ds_write_b128 v234, v[196:199] offset:6656
    s_add_u32 s56, s62, 6656
    buffer_store_dwordx4 v[196:199], v234, s[44:47], s56 offen sc0 sc1
    v_mfma_f32_32x32x16_bf16 v[136:151], v[124:127], v[76:79], v[136:151]
    ds_read_b64_tr_b16 v[100:101], v233 offset:18688
    ds_read_b64_tr_b16 v[102:103], v233 offset:21760
    v_cvt_pk_bf16_f32 v184, v168, v169
    v_cvt_pk_bf16_f32 v185, v170, v171
    s_waitcnt lgkmcnt(10)
    v_mfma_f32_32x32x16_bf16 v[136:151], v[128:131], v[80:83], v[136:151]
    ds_read_b64_tr_b16 v[104:105], v233 offset:24832
    ds_read_b64_tr_b16 v[106:107], v233 offset:27904
    v_cvt_pk_bf16_f32 v186, v172, v173
    v_cvt_pk_bf16_f32 v187, v174, v175
    v_mfma_f32_32x32x16_bf16 v[136:151], v[132:135], v[84:87], v[136:151]
    ds_read_b64_tr_b16 v[108:109], v233 offset:30976
    ds_read_b64_tr_b16 v[110:111], v233 offset:34048
    ds_write_b128 v234, v[184:187] offset:12288
    s_add_u32 s56, s62, 12288
    buffer_store_dwordx4 v[184:187], v234, s[44:47], s56 offen sc0 sc1
    s_waitcnt lgkmcnt(10)
    v_mfma_f32_32x32x16_bf16 v[152:167], v[88:91], v[64:67], 0
    ds_read_b64_tr_b16 v[112:113], v14 offset:256
    ds_read_b64_tr_b16 v[114:115], v14 offset:3328
    v_cvt_pk_bf16_f32 v188, v176, v177
    v_cvt_pk_bf16_f32 v189, v178, v179
    v_mfma_f32_32x32x16_bf16 v[152:167], v[92:95], v[68:71], v[152:167]
    ds_read_b64_tr_b16 v[116:117], v14 offset:6400
    ds_read_b64_tr_b16 v[118:119], v14 offset:9472
    v_cvt_pk_bf16_f32 v190, v180, v181
    v_cvt_pk_bf16_f32 v191, v182, v183
    s_waitcnt lgkmcnt(9)
    v_mfma_f32_32x32x16_bf16 v[152:167], v[96:99], v[72:75], v[152:167]
    ds_read_b64_tr_b16 v[120:121], v14 offset:12544
    ds_read_b64_tr_b16 v[122:123], v14 offset:15616
    ds_write_b128 v234, v[188:191] offset:12800
    s_add_u32 s56, s62, 12800
    buffer_store_dwordx4 v[188:191], v234, s[44:47], s56 offen sc0 sc1
    v_mfma_f32_32x32x16_bf16 v[152:167], v[100:103], v[76:79], v[152:167]
    ds_read_b64_tr_b16 v[124:125], v14 offset:18688
    ds_read_b64_tr_b16 v[126:127], v14 offset:21760
    v_cvt_pk_bf16_f32 v192, v136, v137
    v_cvt_pk_bf16_f32 v193, v138, v139
    s_waitcnt lgkmcnt(10)
    v_mfma_f32_32x32x16_bf16 v[152:167], v[104:107], v[80:83], v[152:167]
    ds_read_b64_tr_b16 v[128:129], v14 offset:24832
    ds_read_b64_tr_b16 v[130:131], v14 offset:27904
    v_cvt_pk_bf16_f32 v194, v140, v141
    v_cvt_pk_bf16_f32 v195, v142, v143
    v_mfma_f32_32x32x16_bf16 v[152:167], v[108:111], v[84:87], v[152:167]
    ds_read_b64_tr_b16 v[132:133], v14 offset:30976
    ds_read_b64_tr_b16 v[134:135], v14 offset:34048
    ds_write_b128 v234, v[192:195] offset:18432
    s_add_u32 s56, s62, 18432
    buffer_store_dwordx4 v[192:195], v234, s[44:47], s56 offen sc0 sc1
    s_waitcnt lgkmcnt(10)
    v_mfma_f32_32x32x16_bf16 v[168:183], v[112:115], v[64:67], 0
    v_cvt_pk_bf16_f32 v196, v144, v145
    v_cvt_pk_bf16_f32 v197, v146, v147
    v_mfma_f32_32x32x16_bf16 v[168:183], v[116:119], v[68:71], v[168:183]
    v_cvt_pk_bf16_f32 v198, v148, v149
    v_cvt_pk_bf16_f32 v199, v150, v151
    s_waitcnt lgkmcnt(5)
    v_mfma_f32_32x32x16_bf16 v[168:183], v[120:123], v[72:75], v[168:183]
    ds_write_b128 v234, v[196:199] offset:18944
    s_add_u32 s56, s62, 18944
    buffer_store_dwordx4 v[196:199], v234, s[44:47], s56 offen sc0 sc1
    v_mfma_f32_32x32x16_bf16 v[168:183], v[124:127], v[76:79], v[168:183]
    v_cvt_pk_bf16_f32 v184, v152, v153
    v_cvt_pk_bf16_f32 v185, v154, v155
    s_waitcnt lgkmcnt(2)
    v_mfma_f32_32x32x16_bf16 v[168:183], v[128:131], v[80:83], v[168:183]
    v_cvt_pk_bf16_f32 v186, v156, v157
    v_cvt_pk_bf16_f32 v187, v158, v159
    v_mfma_f32_32x32x16_bf16 v[168:183], v[132:135], v[84:87], v[168:183]
    ds_write_b128 v234, v[184:187] offset:24576
    s_add_u32 s56, s62, 24576
    buffer_store_dwordx4 v[184:187], v234, s[44:47], s56 offen sc0 sc1
    v_cvt_pk_bf16_f32 v188, v160, v161
    v_cvt_pk_bf16_f32 v189, v162, v163
    v_cvt_pk_bf16_f32 v190, v164, v165
    v_cvt_pk_bf16_f32 v191, v166, v167
    ds_write_b128 v234, v[188:191] offset:25088
    s_add_u32 s56, s62, 25088
    buffer_store_dwordx4 v[188:191], v234, s[44:47], s56 offen sc0 sc1
    s_nop 1
    v_cvt_pk_bf16_f32 v192, v168, v169
    v_cvt_pk_bf16_f32 v193, v170, v171
    v_cvt_pk_bf16_f32 v194, v172, v173
    v_cvt_pk_bf16_f32 v195, v174, v175
    ds_write_b128 v234, v[192:195] offset:30720
    s_add_u32 s56, s62, 30720
    buffer_store_dwordx4 v[192:195], v234, s[44:47], s56 offen sc0 sc1
    v_cvt_pk_bf16_f32 v196, v176, v177
    v_cvt_pk_bf16_f32 v197, v178, v179
    v_cvt_pk_bf16_f32 v198, v180, v181
    v_cvt_pk_bf16_f32 v199, v182, v183
    ds_write_b128 v234, v[196:199] offset:31232
    s_add_u32 s56, s62, 31232
    buffer_store_dwordx4 v[196:199], v234, s[44:47], s56 offen sc0 sc1
    s_waitcnt lgkmcnt(0)
    s_barrier
L_computeC:
    s_mul_i32 s56, s65, 3072
    v_add_u32 v145, s56, v240
    ds_read_b64_tr_b16 v[76:77], v235 offset:0
    ds_read_b64_tr_b16 v[78:79], v235 offset:2560
    ds_read_b128 v[116:119], v145 offset:0
    ds_read_b128 v[120:123], v145 offset:1024
    ds_read_b128 v[124:127], v145 offset:2048
    ds_read_b64_tr_b16 v[80:81], v236 offset:0
    ds_read_b64_tr_b16 v[82:83], v236 offset:2560
    ds_read_b64_tr_b16 v[84:85], v237 offset:0
    ds_read_b64_tr_b16 v[86:87], v237 offset:2560
    ds_read_b64_tr_b16 v[88:89], v238 offset:0
    ds_read_b64_tr_b16 v[90:91], v238 offset:2560
    ds_read_b64_tr_b16 v[92:93], v239 offset:0
    ds_read_b64_tr_b16 v[94:95], v239 offset:2560
    v_add_u32 v146, 122880, v145
    v_add_u32 v140, 40960, v235
    v_add_u32 v141, 40960, v236
    v_add_u32 v142, 40960, v237
    v_add_u32 v143, 40960, v238
    v_add_u32 v144, 40960, v239
    s_waitcnt lgkmcnt(10)
    v_mfma_f32_16x16x32_bf16 v[16:19], v[76:79], v[116:119], 0
    ds_read_b64_tr_b16 v[96:97], v235 offset:10240
    s_waitcnt lgkmcnt(10)
    v_mfma_f32_16x16x32_bf16 v[20:23], v[76:79], v[120:123], 0
    ds_read_b64_tr_b16 v[98:99], v235 offset:12800
    s_waitcnt lgkmcnt(10)
    v_mfma_f32_16x16x32_bf16 v[24:27], v[76:79], v[124:127], 0
    ds_read_b128 v[128:131], v145 offset:6144
    s_waitcnt lgkmcnt(9)
    v_mfma_f32_16x16x32_bf16 v[28:31], v[80:83], v[116:119], 0
    ds_read_b128 v[132:135], v145 offset:7168
    v_mfma_f32_16x16x32_bf16 v[32:35], v[80:83], v[120:123], 0
    ds_read_b128 v[136:139], v145 offset:8192
    v_mfma_f32_16x16x32_bf16 v[36:39], v[80:83], v[124:127], 0
    ds_read_b64_tr_b16 v[100:101], v236 offset:10240
    s_waitcnt lgkmcnt(10)
    v_mfma_f32_16x16x32_bf16 v[40:43], v[84:87], v[116:119], 0
    ds_read_b64_tr_b16 v[102:103], v236 offset:12800
    v_mfma_f32_16x16x32_bf16 v[44:47], v[84:87], v[120:123], 0
    ds_read_b64_tr_b16 v[104:105], v237 offset:10240
    v_mfma_f32_16x16x32_bf16 v[48:51], v[84:87], v[124:127], 0
    ds_read_b64_tr_b16 v[106:107], v237 offset:12800
    s_waitcnt lgkmcnt(11)
    v_mfma_f32_16x16x32_bf16 v[52:55], v[88:91], v[116:119], 0
    ds_read_b64_tr_b16 v[108:109], v238 offset:10240
    v_mfma_f32_16x16x32_bf16 v[56:59], v[88:91], v[120:123], 0
    ds_read_b64_tr_b16 v[110:111], v238 offset:12800
    v_mfma_f32_16x16x32_bf16 v[60:63], v[88:91], v[124:127], 0
    ds_read_b64_tr_b16 v[112:113], v239 offset:10240
    s_waitcnt lgkmcnt(12)
    v_mfma_f32_16x16x32_bf16 v[64:67], v[92:95], v[116:119], 0
    ds_read_b64_tr_b16 v[114:115], v239 offset:12800
    v_mfma_f32_16x16x32_bf16 v[68:71], v[92:95], v[120:123], 0
    v_mfma_f32_16x16x32_bf16 v[72:75], v[92:95], v[124:127], 0
    s_cmp_eq_u32 s20, 3
    s_cbranch_scc1 L_f1done
    s_waitcnt vmcnt(0)
    s_mov_b64 exec, 15
    s_cmp_lg_u32 s26, 0
    s_cbranch_scc1 L_f1fast
    buffer_store_dword v252, v241, s[44:47], 0 offen sc0 sc1
    s_branch L_f1ex
L_f1fast:
    buffer_store_dword v252, v241, s[44:47], 0 offen
L_f1ex:
    s_mov_b64 exec, -1
L_f1done:
    s_waitcnt lgkmcnt(0)
    s_barrier
    v_mfma_f32_16x16x32_bf16 v[16:19], v[96:99], v[128:131], v[16:19]
    ds_read_b64_tr_b16 v[76:77], v235 offset:20480
    v_mfma_f32_16x16x32_bf16 v[20:23], v[96:99], v[132:135], v[20:23]
    ds_read_b64_tr_b16 v[78:79], v235 offset:23040
    v_mfma_f32_16x16x32_bf16 v[24:27], v[96:99], v[136:139], v[24:27]
    ds_read_b128 v[116:119], v145 offset:12288
    v_mfma_f32_16x16x32_bf16 v[28:31], v[100:103], v[128:131], v[28:31]
    ds_read_b128 v[120:123], v145 offset:13312
    v_mfma_f32_16x16x32_bf16 v[32:35], v[100:103], v[132:135], v[32:35]
    ds_read_b128 v[124:127], v145 offset:14336
    v_mfma_f32_16x16x32_bf16 v[36:39], v[100:103], v[136:139], v[36:39]
    ds_read_b64_tr_b16 v[80:81], v236 offset:20480
    v_mfma_f32_16x16x32_bf16 v[40:43], v[104:107], v[128:131], v[40:43]
    ds_read_b64_tr_b16 v[82:83], v236 offset:23040
    v_mfma_f32_16x16x32_bf16 v[44:47], v[104:107], v[132:135], v[44:47]
    ds_read_b64_tr_b16 v[84:85], v237 offset:20480
    v_mfma_f32_16x16x32_bf16 v[48:51], v[104:107], v[136:139], v[48:51]
    ds_read_b64_tr_b16 v[86:87], v237 offset:23040
    v_mfma_f32_16x16x32_bf16 v[52:55], v[108:111], v[128:131], v[52:55]
    ds_read_b64_tr_b16 v[88:89], v238 offset:20480
    v_mfma_f32_16x16x32_bf16 v[56:59], v[108:111], v[132:135], v[56:59]
    ds_read_b64_tr_b16 v[90:91], v238 offset:23040
    v_mfma_f32_16x16x32_bf16 v[60:63], v[108:111], v[136:139], v[60:63]
    ds_read_b64_tr_b16 v[92:93], v239 offset:20480
    v_mfma_f32_16x16x32_bf16 v[64:67], v[112:115], v[128:131], v[64:67]
    ds_read_b64_tr_b16 v[94:95], v239 offset:23040
    v_mfma_f32_16x16x32_bf16 v[68:71], v[112:115], v[132:135], v[68:71]
    v_mfma_f32_16x16x32_bf16 v[72:75], v[112:115], v[136:139], v[72:75]
    s_waitcnt lgkmcnt(10)
    v_mfma_f32_16x16x32_bf16 v[16:19], v[76:79], v[116:119], v[16:19]
    ds_read_b64_tr_b16 v[96:97], v235 offset:30720
    s_waitcnt lgkmcnt(10)
    v_mfma_f32_16x16x32_bf16 v[20:23], v[76:79], v[120:123], v[20:23]
    ds_read_b64_tr_b16 v[98:99], v235 offset:33280
    s_waitcnt lgkmcnt(10)
    v_mfma_f32_16x16x32_bf16 v[24:27], v[76:79], v[124:127], v[24:27]
    ds_read_b128 v[128:131], v145 offset:18432
    s_waitcnt lgkmcnt(9)
    v_mfma_f32_16x16x32_bf16 v[28:31], v[80:83], v[116:119], v[28:31]
    ds_read_b128 v[132:135], v145 offset:19456
    v_mfma_f32_16x16x32_bf16 v[32:35], v[80:83], v[120:123], v[32:35]
    ds_read_b128 v[136:139], v145 offset:20480
    v_mfma_f32_16x16x32_bf16 v[36:39], v[80:83], v[124:127], v[36:39]
    ds_read_b64_tr_b16 v[100:101], v236 offset:30720
    s_waitcnt lgkmcnt(10)
    v_mfma_f32_16x16x32_bf16 v[40:43], v[84:87], v[116:119], v[40:43]
    ds_read_b64_tr_b16 v[102:103], v236 offset:33280
    v_mfma_f32_16x16x32_bf16 v[44:47], v[84:87], v[120:123], v[44:47]
    ds_read_b64_tr_b16 v[104:105], v237 offset:30720
    v_mfma_f32_16x16x32_bf16 v[48:51], v[84:87], v[124:127], v[48:51]
    ds_read_b64_tr_b16 v[106:107], v237 offset:33280
    s_waitcnt lgkmcnt(11)
    v_mfma_f32_16x16x32_bf16 v[52:55], v[88:91], v[116:119], v[52:55]
    ds_read_b64_tr_b16 v[108:109], v238 offset:30720
    v_mfma_f32_16x16x32_bf16 v[56:59], v[88:91], v[120:123], v[56:59]
    ds_read_b64_tr_b16 v[110:111], v238 offset:33280
    v_mfma_f32_16x16x32_bf16 v[60:63], v[88:91], v[124:127], v[60:63]
    ds_read_b64_tr_b16 v[112:113], v239 offset:30720
    s_waitcnt lgkmcnt(12)
    v_mfma_f32_16x16x32_bf16 v[64:67], v[92:95], v[116:119], v[64:67]
    ds_read_b64_tr_b16 v[114:115], v239 offset:33280
    v_mfma_f32_16x16x32_bf16 v[68:71], v[92:95], v[120:123], v[68:71]
    v_mfma_f32_16x16x32_bf16 v[72:75], v[92:95], v[124:127], v[72:75]
    s_waitcnt lgkmcnt(0)
    s_barrier
    v_mfma_f32_16x16x32_bf16 v[16:19], v[96:99], v[128:131], v[16:19]
    ds_read_b64_tr_b16 v[76:77], v140 offset:0
    v_mfma_f32_16x16x32_bf16 v[20:23], v[96:99], v[132:135], v[20:23]
    ds_read_b64_tr_b16 v[78:79], v140 offset:2560
    v_mfma_f32_16x16x32_bf16 v[24:27], v[96:99], v[136:139], v[24:27]
    ds_read_b128 v[116:119], v145 offset:24576
    v_mfma_f32_16x16x32_bf16 v[28:31], v[100:103], v[128:131], v[28:31]
    ds_read_b128 v[120:123], v145 offset:25600
    v_mfma_f32_16x16x32_bf16 v[32:35], v[100:103], v[132:135], v[32:35]
    ds_read_b128 v[124:127], v145 offset:26624
    v_mfma_f32_16x16x32_bf16 v[36:39], v[100:103], v[136:139], v[36:39]
    ds_read_b64_tr_b16 v[80:81], v141 offset:0
    v_mfma_f32_16x16x32_bf16 v[40:43], v[104:107], v[128:131], v[40:43]
    ds_read_b64_tr_b16 v[82:83], v141 offset:2560
    v_mfma_f32_16x16x32_bf16 v[44:47], v[104:107], v[132:135], v[44:47]
    ds_read_b64_tr_b16 v[84:85], v142 offset:0
    v_mfma_f32_16x16x32_bf16 v[48:51], v[104:107], v[136:139], v[48:51]
    ds_read_b64_tr_b16 v[86:87], v142 offset:2560
    v_mfma_f32_16x16x32_bf16 v[52:55], v[108:111], v[128:131], v[52:55]
    ds_read_b64_tr_b16 v[88:89], v143 offset:0
    v_mfma_f32_16x16x32_bf16 v[56:59], v[108:111], v[132:135], v[56:59]
    ds_read_b64_tr_b16 v[90:91], v143 offset:2560
    v_mfma_f32_16x16x32_bf16 v[60:63], v[108:111], v[136:139], v[60:63]
    ds_read_b64_tr_b16 v[92:93], v144 offset:0
    v_mfma_f32_16x16x32_bf16 v[64:67], v[112:115], v[128:131], v[64:67]
    ds_read_b64_tr_b16 v[94:95], v144 offset:2560
    v_mfma_f32_16x16x32_bf16 v[68:71], v[112:115], v[132:135], v[68:71]
    v_mfma_f32_16x16x32_bf16 v[72:75], v[112:115], v[136:139], v[72:75]
    s_waitcnt lgkmcnt(10)
    v_mfma_f32_16x16x32_bf16 v[16:19], v[76:79], v[116:119], v[16:19]
    ds_read_b64_tr_b16 v[96:97], v140 offset:10240
    s_waitcnt lgkmcnt(10)
    v_mfma_f32_16x16x32_bf16 v[20:23], v[76:79], v[120:123], v[20:23]
    ds_read_b64_tr_b16 v[98:99], v140 offset:12800
    s_waitcnt lgkmcnt(10)
    v_mfma_f32_16x16x32_bf16 v[24:27], v[76:79], v[124:127], v[24:27]
    ds_read_b128 v[128:131], v145 offset:30720
    s_waitcnt lgkmcnt(9)
    v_mfma_f32_16x16x32_bf16 v[28:31], v[80:83], v[116:119], v[28:31]
    ds_read_b128 v[132:135], v145 offset:31744
    v_mfma_f32_16x16x32_bf16 v[32:35], v[80:83], v[120:123], v[32:35]
    ds_read_b128 v[136:139], v145 offset:32768
    v_mfma_f32_16x16x32_bf16 v[36:39], v[80:83], v[124:127], v[36:39]
    ds_read_b64_tr_b16 v[100:101], v141 offset:10240
    s_waitcnt lgkmcnt(10)
    v_mfma_f32_16x16x32_bf16 v[40:43], v[84:87], v[116:119], v[40:43]
    ds_read_b64_tr_b16 v[102:103], v141 offset:12800
    v_mfma_f32_16x16x32_bf16 v[44:47], v[84:87], v[120:123], v[44:47]
    ds_read_b64_tr_b16 v[104:105], v142 offset:10240
    v_mfma_f32_16x16x32_bf16 v[48:51], v[84:87], v[124:127], v[48:51]
    ds_read_b64_tr_b16 v[106:107], v142 offset:12800
    s_waitcnt lgkmcnt(11)
    v_mfma_f32_16x16x32_bf16 v[52:55], v[88:91], v[116:119], v[52:55]
    ds_read_b64_tr_b16 v[108:109], v143 offset:10240
    v_mfma_f32_16x16x32_bf16 v[56:59], v[88:91], v[120:123], v[56:59]
    ds_read_b64_tr_b16 v[110:111], v143 offset:12800
    v_mfma_f32_16x16x32_bf16 v[60:63], v[88:91], v[124:127], v[60:63]
    ds_read_b64_tr_b16 v[112:113], v144 offset:10240
    s_waitcnt lgkmcnt(12)
    v_mfma_f32_16x16x32_bf16 v[64:67], v[92:95], v[116:119], v[64:67]
    ds_read_b64_tr_b16 v[114:115], v144 offset:12800
    v_mfma_f32_16x16x32_bf16 v[68:71], v[92:95], v[120:123], v[68:71]
    v_mfma_f32_16x16x32_bf16 v[72:75], v[92:95], v[124:127], v[72:75]
    s_waitcnt lgkmcnt(0)
    s_barrier
    v_mfma_f32_16x16x32_bf16 v[16:19], v[96:99], v[128:131], v[16:19]
    ds_read_b64_tr_b16 v[76:77], v140 offset:20480
    v_mfma_f32_16x16x32_bf16 v[20:23], v[96:99], v[132:135], v[20:23]
    ds_read_b64_tr_b16 v[78:79], v140 offset:23040
    v_mfma_f32_16x16x32_bf16 v[24:27], v[96:99], v[136:139], v[24:27]
    ds_read_b128 v[116:119], v146 offset:0
    v_mfma_f32_16x16x32_bf16 v[28:31], v[100:103], v[128:131], v[28:31]
    ds_read_b128 v[120:123], v146 offset:1024
    v_mfma_f32_16x16x32_bf16 v[32:35], v[100:103], v[132:135], v[32:35]
    ds_read_b128 v[124:127], v146 offset:2048
    v_mfma_f32_16x16x32_bf16 v[36:39], v[100:103], v[136:139], v[36:39]
    ds_read_b64_tr_b16 v[80:81], v141 offset:20480
    v_mfma_f32_16x16x32_bf16 v[40:43], v[104:107], v[128:131], v[40:43]
    ds_read_b64_tr_b16 v[82:83], v141 offset:23040
    v_mfma_f32_16x16x32_bf16 v[44:47], v[104:107], v[132:135], v[44:47]
    ds_read_b64_tr_b16 v[84:85], v142 offset:20480
    v_mfma_f32_16x16x32_bf16 v[48:51], v[104:107], v[136:139], v[48:51]
    ds_read_b64_tr_b16 v[86:87], v142 offset:23040
    v_mfma_f32_16x16x32_bf16 v[52:55], v[108:111], v[128:131], v[52:55]
    ds_read_b64_tr_b16 v[88:89], v143 offset:20480
    v_mfma_f32_16x16x32_bf16 v[56:59], v[108:111], v[132:135], v[56:59]
    ds_read_b64_tr_b16 v[90:91], v143 offset:23040
    v_mfma_f32_16x16x32_bf16 v[60:63], v[108:111], v[136:139], v[60:63]
    ds_read_b64_tr_b16 v[92:93], v144 offset:20480
    v_mfma_f32_16x16x32_bf16 v[64:67], v[112:115], v[128:131], v[64:67]
    ds_read_b64_tr_b16 v[94:95], v144 offset:23040
    v_mfma_f32_16x16x32_bf16 v[68:71], v[112:115], v[132:135], v[68:71]
    v_mfma_f32_16x16x32_bf16 v[72:75], v[112:115], v[136:139], v[72:75]
    s_waitcnt lgkmcnt(10)
    v_mfma_f32_16x16x32_bf16 v[16:19], v[76:79], v[116:119], v[16:19]
    ds_read_b64_tr_b16 v[96:97], v140 offset:30720
    s_waitcnt lgkmcnt(10)
    v_mfma_f32_16x16x32_bf16 v[20:23], v[76:79], v[120:123], v[20:23]
    ds_read_b64_tr_b16 v[98:99], v140 offset:33280
    s_waitcnt lgkmcnt(10)
    v_mfma_f32_16x16x32_bf16 v[24:27], v[76:79], v[124:127], v[24:27]
    ds_read_b128 v[128:131], v146 offset:6144
    s_waitcnt lgkmcnt(9)
    v_mfma_f32_16x16x32_bf16 v[28:31], v[80:83], v[116:119], v[28:31]
    ds_read_b128 v[132:135], v146 offset:7168
    v_mfma_f32_16x16x32_bf16 v[32:35], v[80:83], v[120:123], v[32:35]
    ds_read_b128 v[136:139], v146 offset:8192
    v_mfma_f32_16x16x32_bf16 v[36:39], v[80:83], v[124:127], v[36:39]
    ds_read_b64_tr_b16 v[100:101], v141 offset:30720
    s_waitcnt lgkmcnt(10)
    v_mfma_f32_16x16x32_bf16 v[40:43], v[84:87], v[116:119], v[40:43]
    ds_read_b64_tr_b16 v[102:103], v141 offset:33280
    v_mfma_f32_16x16x32_bf16 v[44:47], v[84:87], v[120:123], v[44:47]
    ds_read_b64_tr_b16 v[104:105], v142 offset:30720
    v_mfma_f32_16x16x32_bf16 v[48:51], v[84:87], v[124:127], v[48:51]
    ds_read_b64_tr_b16 v[106:107], v142 offset:33280
    s_waitcnt lgkmcnt(11)
    v_mfma_f32_16x16x32_bf16 v[52:55], v[88:91], v[116:119], v[52:55]
    ds_read_b64_tr_b16 v[108:109], v143 offset:30720
    v_mfma_f32_16x16x32_bf16 v[56:59], v[88:91], v[120:123], v[56:59]
    ds_read_b64_tr_b16 v[110:111], v143 offset:33280
    v_mfma_f32_16x16x32_bf16 v[60:63], v[88:91], v[124:127], v[60:63]
    ds_read_b64_tr_b16 v[112:113], v144 offset:30720
    s_waitcnt lgkmcnt(12)
    v_mfma_f32_16x16x32_bf16 v[64:67], v[92:95], v[116:119], v[64:67]
    ds_read_b64_tr_b16 v[114:115], v144 offset:33280
    v_mfma_f32_16x16x32_bf16 v[68:71], v[92:95], v[120:123], v[68:71]
    v_mfma_f32_16x16x32_bf16 v[72:75], v[92:95], v[124:127], v[72:75]
    s_waitcnt lgkmcnt(0)
    s_barrier
    v_mfma_f32_16x16x32_bf16 v[16:19], v[96:99], v[128:131], v[16:19]
    ds_read_b64_tr_b16 v[76:77], v235 offset:0
    v_mfma_f32_16x16x32_bf16 v[20:23], v[96:99], v[132:135], v[20:23]
    ds_read_b64_tr_b16 v[78:79], v235 offset:2560
    v_mfma_f32_16x16x32_bf16 v[24:27], v[96:99], v[136:139], v[24:27]
    ds_read_b128 v[116:119], v146 offset:12288
    v_mfma_f32_16x16x32_bf16 v[28:31], v[100:103], v[128:131], v[28:31]
    ds_read_b128 v[120:123], v146 offset:13312
    v_mfma_f32_16x16x32_bf16 v[32:35], v[100:103], v[132:135], v[32:35]
    ds_read_b128 v[124:127], v146 offset:14336
    v_mfma_f32_16x16x32_bf16 v[36:39], v[100:103], v[136:139], v[36:39]
    ds_read_b64_tr_b16 v[80:81], v236 offset:0
    v_mfma_f32_16x16x32_bf16 v[40:43], v[104:107], v[128:131], v[40:43]
    ds_read_b64_tr_b16 v[82:83], v236 offset:2560
    v_mfma_f32_16x16x32_bf16 v[44:47], v[104:107], v[132:135], v[44:47]
    ds_read_b64_tr_b16 v[84:85], v237 offset:0
    v_mfma_f32_16x16x32_bf16 v[48:51], v[104:107], v[136:139], v[48:51]
    ds_read_b64_tr_b16 v[86:87], v237 offset:2560
    v_mfma_f32_16x16x32_bf16 v[52:55], v[108:111], v[128:131], v[52:55]
    ds_read_b64_tr_b16 v[88:89], v238 offset:0
    v_mfma_f32_16x16x32_bf16 v[56:59], v[108:111], v[132:135], v[56:59]
    ds_read_b64_tr_b16 v[90:91], v238 offset:2560
    v_mfma_f32_16x16x32_bf16 v[60:63], v[108:111], v[136:139], v[60:63]
    ds_read_b64_tr_b16 v[92:93], v239 offset:0
    v_mfma_f32_16x16x32_bf16 v[64:67], v[112:115], v[128:131], v[64:67]
    ds_read_b64_tr_b16 v[94:95], v239 offset:2560
    v_mfma_f32_16x16x32_bf16 v[68:71], v[112:115], v[132:135], v[68:71]
    v_mfma_f32_16x16x32_bf16 v[72:75], v[112:115], v[136:139], v[72:75]
    s_waitcnt lgkmcnt(10)
    v_mfma_f32_16x16x32_bf16 v[16:19], v[76:79], v[116:119], v[16:19]
    ds_read_b64_tr_b16 v[96:97], v235 offset:10240
    s_waitcnt lgkmcnt(10)
    v_mfma_f32_16x16x32_bf16 v[20:23], v[76:79], v[120:123], v[20:23]
    ds_read_b64_tr_b16 v[98:99], v235 offset:12800
    s_waitcnt lgkmcnt(10)
    v_mfma_f32_16x16x32_bf16 v[24:27], v[76:79], v[124:127], v[24:27]
    ds_read_b128 v[128:131], v146 offset:18432
    s_waitcnt lgkmcnt(9)
    v_mfma_f32_16x16x32_bf16 v[28:31], v[80:83], v[116:119], v[28:31]
    ds_read_b128 v[132:135], v146 offset:19456
    v_mfma_f32_16x16x32_bf16 v[32:35], v[80:83], v[120:123], v[32:35]
    ds_read_b128 v[136:139], v146 offset:20480
    v_mfma_f32_16x16x32_bf16 v[36:39], v[80:83], v[124:127], v[36:39]
    ds_read_b64_tr_b16 v[100:101], v236 offset:10240
    s_waitcnt lgkmcnt(10)
    v_mfma_f32_16x16x32_bf16 v[40:43], v[84:87], v[116:119], v[40:43]
    ds_read_b64_tr_b16 v[102:103], v236 offset:12800
    v_mfma_f32_16x16x32_bf16 v[44:47], v[84:87], v[120:123], v[44:47]
    ds_read_b64_tr_b16 v[104:105], v237 offset:10240
    v_mfma_f32_16x16x32_bf16 v[48:51], v[84:87], v[124:127], v[48:51]
    ds_read_b64_tr_b16 v[106:107], v237 offset:12800
    s_waitcnt lgkmcnt(11)
    v_mfma_f32_16x16x32_bf16 v[52:55], v[88:91], v[116:119], v[52:55]
    ds_read_b64_tr_b16 v[108:109], v238 offset:10240
    v_mfma_f32_16x16x32_bf16 v[56:59], v[88:91], v[120:123], v[56:59]
    ds_read_b64_tr_b16 v[110:111], v238 offset:12800
    v_mfma_f32_16x16x32_bf16 v[60:63], v[88:91], v[124:127], v[60:63]
    ds_read_b64_tr_b16 v[112:113], v239 offset:10240
    s_waitcnt lgkmcnt(12)
    v_mfma_f32_16x16x32_bf16 v[64:67], v[92:95], v[116:119], v[64:67]
    ds_read_b64_tr_b16 v[114:115], v239 offset:12800
    v_mfma_f32_16x16x32_bf16 v[68:71], v[92:95], v[120:123], v[68:71]
    v_mfma_f32_16x16x32_bf16 v[72:75], v[92:95], v[124:127], v[72:75]
    s_waitcnt lgkmcnt(0)
    s_barrier
    v_mfma_f32_16x16x32_bf16 v[16:19], v[96:99], v[128:131], v[16:19]
    ds_read_b64_tr_b16 v[76:77], v235 offset:20480
    v_mfma_f32_16x16x32_bf16 v[20:23], v[96:99], v[132:135], v[20:23]
    ds_read_b64_tr_b16 v[78:79], v235 offset:23040
    v_mfma_f32_16x16x32_bf16 v[24:27], v[96:99], v[136:139], v[24:27]
    ds_read_b128 v[116:119], v146 offset:24576
    v_mfma_f32_16x16x32_bf16 v[28:31], v[100:103], v[128:131], v[28:31]
    ds_read_b128 v[120:123], v146 offset:25600
    v_mfma_f32_16x16x32_bf16 v[32:35], v[100:103], v[132:135], v[32:35]
    ds_read_b128 v[124:127], v146 offset:26624
    v_mfma_f32_16x16x32_bf16 v[36:39], v[100:103], v[136:139], v[36:39]
    ds_read_b64_tr_b16 v[80:81], v236 offset:20480
    v_mfma_f32_16x16x32_bf16 v[40:43], v[104:107], v[128:131], v[40:43]
    ds_read_b64_tr_b16 v[82:83], v236 offset:23040
    v_mfma_f32_16x16x32_bf16 v[44:47], v[104:107], v[132:135], v[44:47]
    ds_read_b64_tr_b16 v[84:85], v237 offset:20480
    v_mfma_f32_16x16x32_bf16 v[48:51], v[104:107], v[136:139], v[48:51]
    ds_read_b64_tr_b16 v[86:87], v237 offset:23040
    v_mfma_f32_16x16x32_bf16 v[52:55], v[108:111], v[128:131], v[52:55]
    ds_read_b64_tr_b16 v[88:89], v238 offset:20480
    v_mfma_f32_16x16x32_bf16 v[56:59], v[108:111], v[132:135], v[56:59]
    ds_read_b64_tr_b16 v[90:91], v238 offset:23040
    v_mfma_f32_16x16x32_bf16 v[60:63], v[108:111], v[136:139], v[60:63]
    ds_read_b64_tr_b16 v[92:93], v239 offset:20480
    v_mfma_f32_16x16x32_bf16 v[64:67], v[112:115], v[128:131], v[64:67]
    ds_read_b64_tr_b16 v[94:95], v239 offset:23040
    v_mfma_f32_16x16x32_bf16 v[68:71], v[112:115], v[132:135], v[68:71]
    v_mfma_f32_16x16x32_bf16 v[72:75], v[112:115], v[136:139], v[72:75]
    s_waitcnt lgkmcnt(10)
    v_mfma_f32_16x16x32_bf16 v[16:19], v[76:79], v[116:119], v[16:19]
    ds_read_b64_tr_b16 v[96:97], v235 offset:30720
    s_waitcnt lgkmcnt(10)
    v_mfma_f32_16x16x32_bf16 v[20:23], v[76:79], v[120:123], v[20:23]
    ds_read_b64_tr_b16 v[98:99], v235 offset:33280
    s_waitcnt lgkmcnt(10)
    v_mfma_f32_16x16x32_bf16 v[24:27], v[76:79], v[124:127], v[24:27]
    ds_read_b128 v[128:131], v146 offset:30720
    s_waitcnt lgkmcnt(9)
    v_mfma_f32_16x16x32_bf16 v[28:31], v[80:83], v[116:119], v[28:31]
    ds_read_b128 v[132:135], v146 offset:31744
    v_mfma_f32_16x16x32_bf16 v[32:35], v[80:83], v[120:123], v[32:35]
    ds_read_b128 v[136:139], v146 offset:32768
    v_mfma_f32_16x16x32_bf16 v[36:39], v[80:83], v[124:127], v[36:39]
    ds_read_b64_tr_b16 v[100:101], v236 offset:30720
    s_waitcnt lgkmcnt(10)
    v_mfma_f32_16x16x32_bf16 v[40:43], v[84:87], v[116:119], v[40:43]
    ds_read_b64_tr_b16 v[102:103], v236 offset:33280
    v_mfma_f32_16x16x32_bf16 v[44:47], v[84:87], v[120:123], v[44:47]
    ds_read_b64_tr_b16 v[104:105], v237 offset:30720
    v_mfma_f32_16x16x32_bf16 v[48:51], v[84:87], v[124:127], v[48:51]
    ds_read_b64_tr_b16 v[106:107], v237 offset:33280
    s_waitcnt lgkmcnt(11)
    v_mfma_f32_16x16x32_bf16 v[52:55], v[88:91], v[116:119], v[52:55]
    ds_read_b64_tr_b16 v[108:109], v238 offset:30720
    v_mfma_f32_16x16x32_bf16 v[56:59], v[88:91], v[120:123], v[56:59]
    ds_read_b64_tr_b16 v[110:111], v238 offset:33280
    v_mfma_f32_16x16x32_bf16 v[60:63], v[88:91], v[124:127], v[60:63]
    ds_read_b64_tr_b16 v[112:113], v239 offset:30720
    s_waitcnt lgkmcnt(12)
    v_mfma_f32_16x16x32_bf16 v[64:67], v[92:95], v[116:119], v[64:67]
    ds_read_b64_tr_b16 v[114:115], v239 offset:33280
    v_mfma_f32_16x16x32_bf16 v[68:71], v[92:95], v[120:123], v[68:71]
    v_mfma_f32_16x16x32_bf16 v[72:75], v[92:95], v[124:127], v[72:75]
    s_waitcnt lgkmcnt(0)
    s_barrier
    v_mfma_f32_16x16x32_bf16 v[16:19], v[96:99], v[128:131], v[16:19]
    ds_read_b64_tr_b16 v[76:77], v140 offset:0
    v_mfma_f32_16x16x32_bf16 v[20:23], v[96:99], v[132:135], v[20:23]
    ds_read_b64_tr_b16 v[78:79], v140 offset:2560
    v_mfma_f32_16x16x32_bf16 v[24:27], v[96:99], v[136:139], v[24:27]
    ds_read_b128 v[116:119], v146 offset:0
    v_mfma_f32_16x16x32_bf16 v[28:31], v[100:103], v[128:131], v[28:31]
    ds_read_b128 v[120:123], v146 offset:1024
    v_mfma_f32_16x16x32_bf16 v[32:35], v[100:103], v[132:135], v[32:35]
    ds_read_b128 v[124:127], v146 offset:2048
    v_mfma_f32_16x16x32_bf16 v[36:39], v[100:103], v[136:139], v[36:39]
    ds_read_b64_tr_b16 v[80:81], v141 offset:0
    v_mfma_f32_16x16x32_bf16 v[40:43], v[104:107], v[128:131], v[40:43]
    ds_read_b64_tr_b16 v[82:83], v141 offset:2560
    v_mfma_f32_16x16x32_bf16 v[44:47], v[104:107], v[132:135], v[44:47]
    ds_read_b64_tr_b16 v[84:85], v142 offset:0
    v_mfma_f32_16x16x32_bf16 v[48:51], v[104:107], v[136:139], v[48:51]
    ds_read_b64_tr_b16 v[86:87], v142 offset:2560
    v_mfma_f32_16x16x32_bf16 v[52:55], v[108:111], v[128:131], v[52:55]
    ds_read_b64_tr_b16 v[88:89], v143 offset:0
    v_mfma_f32_16x16x32_bf16 v[56:59], v[108:111], v[132:135], v[56:59]
    ds_read_b64_tr_b16 v[90:91], v143 offset:2560
    v_mfma_f32_16x16x32_bf16 v[60:63], v[108:111], v[136:139], v[60:63]
    ds_read_b64_tr_b16 v[92:93], v144 offset:0
    v_mfma_f32_16x16x32_bf16 v[64:67], v[112:115], v[128:131], v[64:67]
    ds_read_b64_tr_b16 v[94:95], v144 offset:2560
    v_mfma_f32_16x16x32_bf16 v[68:71], v[112:115], v[132:135], v[68:71]
    v_mfma_f32_16x16x32_bf16 v[72:75], v[112:115], v[136:139], v[72:75]
    s_waitcnt lgkmcnt(10)
    v_mfma_f32_16x16x32_bf16 v[16:19], v[76:79], v[116:119], v[16:19]
    ds_read_b64_tr_b16 v[96:97], v140 offset:10240
    s_waitcnt lgkmcnt(10)
    v_mfma_f32_16x16x32_bf16 v[20:23], v[76:79], v[120:123], v[20:23]
    ds_read_b64_tr_b16 v[98:99], v140 offset:12800
    s_waitcnt lgkmcnt(10)
    v_mfma_f32_16x16x32_bf16 v[24:27], v[76:79], v[124:127], v[24:27]
    ds_read_b128 v[128:131], v146 offset:6144
    s_waitcnt lgkmcnt(9)
    v_mfma_f32_16x16x32_bf16 v[28:31], v[80:83], v[116:119], v[28:31]
    ds_read_b128 v[132:135], v146 offset:7168
    v_mfma_f32_16x16x32_bf16 v[32:35], v[80:83], v[120:123], v[32:35]
    ds_read_b128 v[136:139], v146 offset:8192
    v_mfma_f32_16x16x32_bf16 v[36:39], v[80:83], v[124:127], v[36:39]
    ds_read_b64_tr_b16 v[100:101], v141 offset:10240
    s_waitcnt lgkmcnt(10)
    v_mfma_f32_16x16x32_bf16 v[40:43], v[84:87], v[116:119], v[40:43]
    ds_read_b64_tr_b16 v[102:103], v141 offset:12800
    v_mfma_f32_16x16x32_bf16 v[44:47], v[84:87], v[120:123], v[44:47]
    ds_read_b64_tr_b16 v[104:105], v142 offset:10240
    v_mfma_f32_16x16x32_bf16 v[48:51], v[84:87], v[124:127], v[48:51]
    ds_read_b64_tr_b16 v[106:107], v142 offset:12800
    s_waitcnt lgkmcnt(11)
    v_mfma_f32_16x16x32_bf16 v[52:55], v[88:91], v[116:119], v[52:55]
    ds_read_b64_tr_b16 v[108:109], v143 offset:10240
    v_mfma_f32_16x16x32_bf16 v[56:59], v[88:91], v[120:123], v[56:59]
    ds_read_b64_tr_b16 v[110:111], v143 offset:12800
    v_mfma_f32_16x16x32_bf16 v[60:63], v[88:91], v[124:127], v[60:63]
    ds_read_b64_tr_b16 v[112:113], v144 offset:10240
    s_waitcnt lgkmcnt(12)
    v_mfma_f32_16x16x32_bf16 v[64:67], v[92:95], v[116:119], v[64:67]
    ds_read_b64_tr_b16 v[114:115], v144 offset:12800
    v_mfma_f32_16x16x32_bf16 v[68:71], v[92:95], v[120:123], v[68:71]
    v_mfma_f32_16x16x32_bf16 v[72:75], v[92:95], v[124:127], v[72:75]
    s_waitcnt lgkmcnt(0)
    s_barrier
    v_mfma_f32_16x16x32_bf16 v[16:19], v[96:99], v[128:131], v[16:19]
    ds_read_b64_tr_b16 v[76:77], v140 offset:20480
    v_mfma_f32_16x16x32_bf16 v[20:23], v[96:99], v[132:135], v[20:23]
    ds_read_b64_tr_b16 v[78:79], v140 offset:23040
    v_mfma_f32_16x16x32_bf16 v[24:27], v[96:99], v[136:139], v[24:27]
    ds_read_b128 v[116:119], v146 offset:12288
    v_mfma_f32_16x16x32_bf16 v[28:31], v[100:103], v[128:131], v[28:31]
    ds_read_b128 v[120:123], v146 offset:13312
    v_mfma_f32_16x16x32_bf16 v[32:35], v[100:103], v[132:135], v[32:35]
    ds_read_b128 v[124:127], v146 offset:14336
    v_mfma_f32_16x16x32_bf16 v[36:39], v[100:103], v[136:139], v[36:39]
    ds_read_b64_tr_b16 v[80:81], v141 offset:20480
    v_mfma_f32_16x16x32_bf16 v[40:43], v[104:107], v[128:131], v[40:43]
    ds_read_b64_tr_b16 v[82:83], v141 offset:23040
    v_mfma_f32_16x16x32_bf16 v[44:47], v[104:107], v[132:135], v[44:47]
    ds_read_b64_tr_b16 v[84:85], v142 offset:20480
    v_mfma_f32_16x16x32_bf16 v[48:51], v[104:107], v[136:139], v[48:51]
    ds_read_b64_tr_b16 v[86:87], v142 offset:23040
    v_mfma_f32_16x16x32_bf16 v[52:55], v[108:111], v[128:131], v[52:55]
    ds_read_b64_tr_b16 v[88:89], v143 offset:20480
    v_mfma_f32_16x16x32_bf16 v[56:59], v[108:111], v[132:135], v[56:59]
    ds_read_b64_tr_b16 v[90:91], v143 offset:23040
    v_mfma_f32_16x16x32_bf16 v[60:63], v[108:111], v[136:139], v[60:63]
    ds_read_b64_tr_b16 v[92:93], v144 offset:20480
    v_mfma_f32_16x16x32_bf16 v[64:67], v[112:115], v[128:131], v[64:67]
    ds_read_b64_tr_b16 v[94:95], v144 offset:23040
    v_mfma_f32_16x16x32_bf16 v[68:71], v[112:115], v[132:135], v[68:71]
    v_mfma_f32_16x16x32_bf16 v[72:75], v[112:115], v[136:139], v[72:75]
    s_waitcnt lgkmcnt(10)
    v_mfma_f32_16x16x32_bf16 v[16:19], v[76:79], v[116:119], v[16:19]
    ds_read_b64_tr_b16 v[96:97], v140 offset:30720
    s_waitcnt lgkmcnt(10)
    v_mfma_f32_16x16x32_bf16 v[20:23], v[76:79], v[120:123], v[20:23]
    ds_read_b64_tr_b16 v[98:99], v140 offset:33280
    s_waitcnt lgkmcnt(10)
    v_mfma_f32_16x16x32_bf16 v[24:27], v[76:79], v[124:127], v[24:27]
    ds_read_b128 v[128:131], v146 offset:18432
    s_waitcnt lgkmcnt(9)
    v_mfma_f32_16x16x32_bf16 v[28:31], v[80:83], v[116:119], v[28:31]
    ds_read_b128 v[132:135], v146 offset:19456
    v_mfma_f32_16x16x32_bf16 v[32:35], v[80:83], v[120:123], v[32:35]
    ds_read_b128 v[136:139], v146 offset:20480
    v_mfma_f32_16x16x32_bf16 v[36:39], v[80:83], v[124:127], v[36:39]
    ds_read_b64_tr_b16 v[100:101], v141 offset:30720
    s_waitcnt lgkmcnt(10)
    v_mfma_f32_16x16x32_bf16 v[40:43], v[84:87], v[116:119], v[40:43]
    ds_read_b64_tr_b16 v[102:103], v141 offset:33280
    v_mfma_f32_16x16x32_bf16 v[44:47], v[84:87], v[120:123], v[44:47]
    ds_read_b64_tr_b16 v[104:105], v142 offset:30720
    v_mfma_f32_16x16x32_bf16 v[48:51], v[84:87], v[124:127], v[48:51]
    ds_read_b64_tr_b16 v[106:107], v142 offset:33280
    s_waitcnt lgkmcnt(11)
    v_mfma_f32_16x16x32_bf16 v[52:55], v[88:91], v[116:119], v[52:55]
    ds_read_b64_tr_b16 v[108:109], v143 offset:30720
    v_mfma_f32_16x16x32_bf16 v[56:59], v[88:91], v[120:123], v[56:59]
    ds_read_b64_tr_b16 v[110:111], v143 offset:33280
    v_mfma_f32_16x16x32_bf16 v[60:63], v[88:91], v[124:127], v[60:63]
    ds_read_b64_tr_b16 v[112:113], v144 offset:30720
    s_waitcnt lgkmcnt(12)
    v_mfma_f32_16x16x32_bf16 v[64:67], v[92:95], v[116:119], v[64:67]
    ds_read_b64_tr_b16 v[114:115], v144 offset:33280
    v_mfma_f32_16x16x32_bf16 v[68:71], v[92:95], v[120:123], v[68:71]
    v_mfma_f32_16x16x32_bf16 v[72:75], v[92:95], v[124:127], v[72:75]
    s_waitcnt lgkmcnt(0)
    s_barrier
    v_mfma_f32_16x16x32_bf16 v[16:19], v[96:99], v[128:131], v[16:19]
    ds_read_b64_tr_b16 v[76:77], v235 offset:0
    v_mfma_f32_16x16x32_bf16 v[20:23], v[96:99], v[132:135], v[20:23]
    ds_read_b64_tr_b16 v[78:79], v235 offset:2560
    v_mfma_f32_16x16x32_bf16 v[24:27], v[96:99], v[136:139], v[24:27]
    ds_read_b128 v[116:119], v146 offset:24576
    v_mfma_f32_16x16x32_bf16 v[28:31], v[100:103], v[128:131], v[28:31]
    ds_read_b128 v[120:123], v146 offset:25600
    v_mfma_f32_16x16x32_bf16 v[32:35], v[100:103], v[132:135], v[32:35]
    ds_read_b128 v[124:127], v146 offset:26624
    v_mfma_f32_16x16x32_bf16 v[36:39], v[100:103], v[136:139], v[36:39]
    ds_read_b64_tr_b16 v[80:81], v236 offset:0
    v_mfma_f32_16x16x32_bf16 v[40:43], v[104:107], v[128:131], v[40:43]
    ds_read_b64_tr_b16 v[82:83], v236 offset:2560
    v_mfma_f32_16x16x32_bf16 v[44:47], v[104:107], v[132:135], v[44:47]
    ds_read_b64_tr_b16 v[84:85], v237 offset:0
    v_mfma_f32_16x16x32_bf16 v[48:51], v[104:107], v[136:139], v[48:51]
    ds_read_b64_tr_b16 v[86:87], v237 offset:2560
    v_mfma_f32_16x16x32_bf16 v[52:55], v[108:111], v[128:131], v[52:55]
    ds_read_b64_tr_b16 v[88:89], v238 offset:0
    v_mfma_f32_16x16x32_bf16 v[56:59], v[108:111], v[132:135], v[56:59]
    ds_read_b64_tr_b16 v[90:91], v238 offset:2560
    v_mfma_f32_16x16x32_bf16 v[60:63], v[108:111], v[136:139], v[60:63]
    ds_read_b64_tr_b16 v[92:93], v239 offset:0
    v_mfma_f32_16x16x32_bf16 v[64:67], v[112:115], v[128:131], v[64:67]
    ds_read_b64_tr_b16 v[94:95], v239 offset:2560
    v_mfma_f32_16x16x32_bf16 v[68:71], v[112:115], v[132:135], v[68:71]
    v_mfma_f32_16x16x32_bf16 v[72:75], v[112:115], v[136:139], v[72:75]
    s_waitcnt lgkmcnt(10)
    v_mfma_f32_16x16x32_bf16 v[16:19], v[76:79], v[116:119], v[16:19]
    ds_read_b64_tr_b16 v[96:97], v235 offset:10240
    s_waitcnt lgkmcnt(10)
    v_mfma_f32_16x16x32_bf16 v[20:23], v[76:79], v[120:123], v[20:23]
    ds_read_b64_tr_b16 v[98:99], v235 offset:12800
    s_waitcnt lgkmcnt(10)
    v_mfma_f32_16x16x32_bf16 v[24:27], v[76:79], v[124:127], v[24:27]
    ds_read_b128 v[128:131], v146 offset:30720
    s_waitcnt lgkmcnt(9)
    v_mfma_f32_16x16x32_bf16 v[28:31], v[80:83], v[116:119], v[28:31]
    ds_read_b128 v[132:135], v146 offset:31744
    v_mfma_f32_16x16x32_bf16 v[32:35], v[80:83], v[120:123], v[32:35]
    ds_read_b128 v[136:139], v146 offset:32768
    v_mfma_f32_16x16x32_bf16 v[36:39], v[80:83], v[124:127], v[36:39]
    ds_read_b64_tr_b16 v[100:101], v236 offset:10240
    s_waitcnt lgkmcnt(10)
    v_mfma_f32_16x16x32_bf16 v[40:43], v[84:87], v[116:119], v[40:43]
    ds_read_b64_tr_b16 v[102:103], v236 offset:12800
    v_mfma_f32_16x16x32_bf16 v[44:47], v[84:87], v[120:123], v[44:47]
    ds_read_b64_tr_b16 v[104:105], v237 offset:10240
    v_mfma_f32_16x16x32_bf16 v[48:51], v[84:87], v[124:127], v[48:51]
    ds_read_b64_tr_b16 v[106:107], v237 offset:12800
    s_waitcnt lgkmcnt(11)
    v_mfma_f32_16x16x32_bf16 v[52:55], v[88:91], v[116:119], v[52:55]
    ds_read_b64_tr_b16 v[108:109], v238 offset:10240
    v_mfma_f32_16x16x32_bf16 v[56:59], v[88:91], v[120:123], v[56:59]
    ds_read_b64_tr_b16 v[110:111], v238 offset:12800
    v_mfma_f32_16x16x32_bf16 v[60:63], v[88:91], v[124:127], v[60:63]
    ds_read_b64_tr_b16 v[112:113], v239 offset:10240
    s_waitcnt lgkmcnt(12)
    v_mfma_f32_16x16x32_bf16 v[64:67], v[92:95], v[116:119], v[64:67]
    ds_read_b64_tr_b16 v[114:115], v239 offset:12800
    v_mfma_f32_16x16x32_bf16 v[68:71], v[92:95], v[120:123], v[68:71]
    v_mfma_f32_16x16x32_bf16 v[72:75], v[92:95], v[124:127], v[72:75]
    s_waitcnt lgkmcnt(0)
    s_barrier
    v_mfma_f32_16x16x32_bf16 v[16:19], v[96:99], v[128:131], v[16:19]
    ds_read_b64_tr_b16 v[76:77], v235 offset:20480
    v_mfma_f32_16x16x32_bf16 v[20:23], v[96:99], v[132:135], v[20:23]
    ds_read_b64_tr_b16 v[78:79], v235 offset:23040
    v_mfma_f32_16x16x32_bf16 v[24:27], v[96:99], v[136:139], v[24:27]
    ds_read_b128 v[116:119], v146 offset:0
    v_mfma_f32_16x16x32_bf16 v[28:31], v[100:103], v[128:131], v[28:31]
    ds_read_b128 v[120:123], v146 offset:1024
    v_mfma_f32_16x16x32_bf16 v[32:35], v[100:103], v[132:135], v[32:35]
    ds_read_b128 v[124:127], v146 offset:2048
    v_mfma_f32_16x16x32_bf16 v[36:39], v[100:103], v[136:139], v[36:39]
    ds_read_b64_tr_b16 v[80:81], v236 offset:20480
    v_mfma_f32_16x16x32_bf16 v[40:43], v[104:107], v[128:131], v[40:43]
    ds_read_b64_tr_b16 v[82:83], v236 offset:23040
    v_mfma_f32_16x16x32_bf16 v[44:47], v[104:107], v[132:135], v[44:47]
    ds_read_b64_tr_b16 v[84:85], v237 offset:20480
    v_mfma_f32_16x16x32_bf16 v[48:51], v[104:107], v[136:139], v[48:51]
    ds_read_b64_tr_b16 v[86:87], v237 offset:23040
    v_mfma_f32_16x16x32_bf16 v[52:55], v[108:111], v[128:131], v[52:55]
    ds_read_b64_tr_b16 v[88:89], v238 offset:20480
    v_mfma_f32_16x16x32_bf16 v[56:59], v[108:111], v[132:135], v[56:59]
    ds_read_b64_tr_b16 v[90:91], v238 offset:23040
    v_mfma_f32_16x16x32_bf16 v[60:63], v[108:111], v[136:139], v[60:63]
    ds_read_b64_tr_b16 v[92:93], v239 offset:20480
    v_mfma_f32_16x16x32_bf16 v[64:67], v[112:115], v[128:131], v[64:67]
    ds_read_b64_tr_b16 v[94:95], v239 offset:23040
    v_mfma_f32_16x16x32_bf16 v[68:71], v[112:115], v[132:135], v[68:71]
    v_mfma_f32_16x16x32_bf16 v[72:75], v[112:115], v[136:139], v[72:75]
    s_waitcnt lgkmcnt(10)
    v_mfma_f32_16x16x32_bf16 v[16:19], v[76:79], v[116:119], v[16:19]
    ds_read_b64_tr_b16 v[96:97], v235 offset:30720
    s_waitcnt lgkmcnt(10)
    v_mfma_f32_16x16x32_bf16 v[20:23], v[76:79], v[120:123], v[20:23]
    ds_read_b64_tr_b16 v[98:99], v235 offset:33280
    s_waitcnt lgkmcnt(10)
    v_mfma_f32_16x16x32_bf16 v[24:27], v[76:79], v[124:127], v[24:27]
    ds_read_b128 v[128:131], v146 offset:6144
    s_waitcnt lgkmcnt(9)
    v_mfma_f32_16x16x32_bf16 v[28:31], v[80:83], v[116:119], v[28:31]
    ds_read_b128 v[132:135], v146 offset:7168
    v_mfma_f32_16x16x32_bf16 v[32:35], v[80:83], v[120:123], v[32:35]
    ds_read_b128 v[136:139], v146 offset:8192
    v_mfma_f32_16x16x32_bf16 v[36:39], v[80:83], v[124:127], v[36:39]
    ds_read_b64_tr_b16 v[100:101], v236 offset:30720
    s_waitcnt lgkmcnt(10)
    v_mfma_f32_16x16x32_bf16 v[40:43], v[84:87], v[116:119], v[40:43]
    ds_read_b64_tr_b16 v[102:103], v236 offset:33280
    v_mfma_f32_16x16x32_bf16 v[44:47], v[84:87], v[120:123], v[44:47]
    ds_read_b64_tr_b16 v[104:105], v237 offset:30720
    v_mfma_f32_16x16x32_bf16 v[48:51], v[84:87], v[124:127], v[48:51]
    ds_read_b64_tr_b16 v[106:107], v237 offset:33280
    s_waitcnt lgkmcnt(11)
    v_mfma_f32_16x16x32_bf16 v[52:55], v[88:91], v[116:119], v[52:55]
    ds_read_b64_tr_b16 v[108:109], v238 offset:30720
    v_mfma_f32_16x16x32_bf16 v[56:59], v[88:91], v[120:123], v[56:59]
    ds_read_b64_tr_b16 v[110:111], v238 offset:33280
    v_mfma_f32_16x16x32_bf16 v[60:63], v[88:91], v[124:127], v[60:63]
    ds_read_b64_tr_b16 v[112:113], v239 offset:30720
    s_waitcnt lgkmcnt(12)
    v_mfma_f32_16x16x32_bf16 v[64:67], v[92:95], v[116:119], v[64:67]
    ds_read_b64_tr_b16 v[114:115], v239 offset:33280
    v_mfma_f32_16x16x32_bf16 v[68:71], v[92:95], v[120:123], v[68:71]
    v_mfma_f32_16x16x32_bf16 v[72:75], v[92:95], v[124:127], v[72:75]
    s_waitcnt lgkmcnt(0)
    s_barrier
    v_mfma_f32_16x16x32_bf16 v[16:19], v[96:99], v[128:131], v[16:19]
    ds_read_b64_tr_b16 v[76:77], v140 offset:0
    v_mfma_f32_16x16x32_bf16 v[20:23], v[96:99], v[132:135], v[20:23]
    ds_read_b64_tr_b16 v[78:79], v140 offset:2560
    v_mfma_f32_16x16x32_bf16 v[24:27], v[96:99], v[136:139], v[24:27]
    ds_read_b128 v[116:119], v146 offset:12288
    v_mfma_f32_16x16x32_bf16 v[28:31], v[100:103], v[128:131], v[28:31]
    ds_read_b128 v[120:123], v146 offset:13312
    v_mfma_f32_16x16x32_bf16 v[32:35], v[100:103], v[132:135], v[32:35]
    ds_read_b128 v[124:127], v146 offset:14336
    v_mfma_f32_16x16x32_bf16 v[36:39], v[100:103], v[136:139], v[36:39]
    ds_read_b64_tr_b16 v[80:81], v141 offset:0
    v_mfma_f32_16x16x32_bf16 v[40:43], v[104:107], v[128:131], v[40:43]
    ds_read_b64_tr_b16 v[82:83], v141 offset:2560
    v_mfma_f32_16x16x32_bf16 v[44:47], v[104:107], v[132:135], v[44:47]
    ds_read_b64_tr_b16 v[84:85], v142 offset:0
    v_mfma_f32_16x16x32_bf16 v[48:51], v[104:107], v[136:139], v[48:51]
    ds_read_b64_tr_b16 v[86:87], v142 offset:2560
    v_mfma_f32_16x16x32_bf16 v[52:55], v[108:111], v[128:131], v[52:55]
    ds_read_b64_tr_b16 v[88:89], v143 offset:0
    v_mfma_f32_16x16x32_bf16 v[56:59], v[108:111], v[132:135], v[56:59]
    ds_read_b64_tr_b16 v[90:91], v143 offset:2560
    v_mfma_f32_16x16x32_bf16 v[60:63], v[108:111], v[136:139], v[60:63]
    ds_read_b64_tr_b16 v[92:93], v144 offset:0
    v_mfma_f32_16x16x32_bf16 v[64:67], v[112:115], v[128:131], v[64:67]
    ds_read_b64_tr_b16 v[94:95], v144 offset:2560
    v_mfma_f32_16x16x32_bf16 v[68:71], v[112:115], v[132:135], v[68:71]
    v_mfma_f32_16x16x32_bf16 v[72:75], v[112:115], v[136:139], v[72:75]
    s_waitcnt lgkmcnt(10)
    v_mfma_f32_16x16x32_bf16 v[16:19], v[76:79], v[116:119], v[16:19]
    ds_read_b64_tr_b16 v[96:97], v140 offset:10240
    s_waitcnt lgkmcnt(10)
    v_mfma_f32_16x16x32_bf16 v[20:23], v[76:79], v[120:123], v[20:23]
    ds_read_b64_tr_b16 v[98:99], v140 offset:12800
    s_waitcnt lgkmcnt(10)
    v_mfma_f32_16x16x32_bf16 v[24:27], v[76:79], v[124:127], v[24:27]
    ds_read_b128 v[128:131], v146 offset:18432
    s_waitcnt lgkmcnt(9)
    v_mfma_f32_16x16x32_bf16 v[28:31], v[80:83], v[116:119], v[28:31]
    ds_read_b128 v[132:135], v146 offset:19456
    v_mfma_f32_16x16x32_bf16 v[32:35], v[80:83], v[120:123], v[32:35]
    ds_read_b128 v[136:139], v146 offset:20480
    v_mfma_f32_16x16x32_bf16 v[36:39], v[80:83], v[124:127], v[36:39]
    ds_read_b64_tr_b16 v[100:101], v141 offset:10240
    s_waitcnt lgkmcnt(10)
    v_mfma_f32_16x16x32_bf16 v[40:43], v[84:87], v[116:119], v[40:43]
    ds_read_b64_tr_b16 v[102:103], v141 offset:12800
    v_mfma_f32_16x16x32_bf16 v[44:47], v[84:87], v[120:123], v[44:47]
    ds_read_b64_tr_b16 v[104:105], v142 offset:10240
    v_mfma_f32_16x16x32_bf16 v[48:51], v[84:87], v[124:127], v[48:51]
    ds_read_b64_tr_b16 v[106:107], v142 offset:12800
    s_waitcnt lgkmcnt(11)
    v_mfma_f32_16x16x32_bf16 v[52:55], v[88:91], v[116:119], v[52:55]
    ds_read_b64_tr_b16 v[108:109], v143 offset:10240
    v_mfma_f32_16x16x32_bf16 v[56:59], v[88:91], v[120:123], v[56:59]
    ds_read_b64_tr_b16 v[110:111], v143 offset:12800
    v_mfma_f32_16x16x32_bf16 v[60:63], v[88:91], v[124:127], v[60:63]
    ds_read_b64_tr_b16 v[112:113], v144 offset:10240
    s_waitcnt lgkmcnt(12)
    v_mfma_f32_16x16x32_bf16 v[64:67], v[92:95], v[116:119], v[64:67]
    ds_read_b64_tr_b16 v[114:115], v144 offset:12800
    v_mfma_f32_16x16x32_bf16 v[68:71], v[92:95], v[120:123], v[68:71]
    v_mfma_f32_16x16x32_bf16 v[72:75], v[92:95], v[124:127], v[72:75]
    s_waitcnt lgkmcnt(0)
    s_barrier
    v_mfma_f32_16x16x32_bf16 v[16:19], v[96:99], v[128:131], v[16:19]
    ds_read_b64_tr_b16 v[76:77], v140 offset:20480
    v_mfma_f32_16x16x32_bf16 v[20:23], v[96:99], v[132:135], v[20:23]
    ds_read_b64_tr_b16 v[78:79], v140 offset:23040
    v_mfma_f32_16x16x32_bf16 v[24:27], v[96:99], v[136:139], v[24:27]
    ds_read_b128 v[116:119], v146 offset:24576
    v_mfma_f32_16x16x32_bf16 v[28:31], v[100:103], v[128:131], v[28:31]
    ds_read_b128 v[120:123], v146 offset:25600
    v_mfma_f32_16x16x32_bf16 v[32:35], v[100:103], v[132:135], v[32:35]
    ds_read_b128 v[124:127], v146 offset:26624
    v_mfma_f32_16x16x32_bf16 v[36:39], v[100:103], v[136:139], v[36:39]
    ds_read_b64_tr_b16 v[80:81], v141 offset:20480
    v_mfma_f32_16x16x32_bf16 v[40:43], v[104:107], v[128:131], v[40:43]
    ds_read_b64_tr_b16 v[82:83], v141 offset:23040
    v_mfma_f32_16x16x32_bf16 v[44:47], v[104:107], v[132:135], v[44:47]
    ds_read_b64_tr_b16 v[84:85], v142 offset:20480
    v_mfma_f32_16x16x32_bf16 v[48:51], v[104:107], v[136:139], v[48:51]
    ds_read_b64_tr_b16 v[86:87], v142 offset:23040
    v_mfma_f32_16x16x32_bf16 v[52:55], v[108:111], v[128:131], v[52:55]
    ds_read_b64_tr_b16 v[88:89], v143 offset:20480
    v_mfma_f32_16x16x32_bf16 v[56:59], v[108:111], v[132:135], v[56:59]
    ds_read_b64_tr_b16 v[90:91], v143 offset:23040
    v_mfma_f32_16x16x32_bf16 v[60:63], v[108:111], v[136:139], v[60:63]
    ds_read_b64_tr_b16 v[92:93], v144 offset:20480
    v_mfma_f32_16x16x32_bf16 v[64:67], v[112:115], v[128:131], v[64:67]
    ds_read_b64_tr_b16 v[94:95], v144 offset:23040
    v_mfma_f32_16x16x32_bf16 v[68:71], v[112:115], v[132:135], v[68:71]
    v_mfma_f32_16x16x32_bf16 v[72:75], v[112:115], v[136:139], v[72:75]
    s_waitcnt lgkmcnt(10)
    v_mfma_f32_16x16x32_bf16 v[16:19], v[76:79], v[116:119], v[16:19]
    ds_read_b64_tr_b16 v[96:97], v140 offset:30720
    s_waitcnt lgkmcnt(10)
    v_mfma_f32_16x16x32_bf16 v[20:23], v[76:79], v[120:123], v[20:23]
    ds_read_b64_tr_b16 v[98:99], v140 offset:33280
    s_waitcnt lgkmcnt(10)
    v_mfma_f32_16x16x32_bf16 v[24:27], v[76:79], v[124:127], v[24:27]
    ds_read_b128 v[128:131], v146 offset:30720
    s_waitcnt lgkmcnt(9)
    v_mfma_f32_16x16x32_bf16 v[28:31], v[80:83], v[116:119], v[28:31]
    ds_read_b128 v[132:135], v146 offset:31744
    v_mfma_f32_16x16x32_bf16 v[32:35], v[80:83], v[120:123], v[32:35]
    ds_read_b128 v[136:139], v146 offset:32768
    v_mfma_f32_16x16x32_bf16 v[36:39], v[80:83], v[124:127], v[36:39]
    ds_read_b64_tr_b16 v[100:101], v141 offset:30720
    s_waitcnt lgkmcnt(10)
    v_mfma_f32_16x16x32_bf16 v[40:43], v[84:87], v[116:119], v[40:43]
    ds_read_b64_tr_b16 v[102:103], v141 offset:33280
    v_mfma_f32_16x16x32_bf16 v[44:47], v[84:87], v[120:123], v[44:47]
    ds_read_b64_tr_b16 v[104:105], v142 offset:30720
    v_mfma_f32_16x16x32_bf16 v[48:51], v[84:87], v[124:127], v[48:51]
    ds_read_b64_tr_b16 v[106:107], v142 offset:33280
    s_waitcnt lgkmcnt(11)
    v_mfma_f32_16x16x32_bf16 v[52:55], v[88:91], v[116:119], v[52:55]
    ds_read_b64_tr_b16 v[108:109], v143 offset:30720
    v_mfma_f32_16x16x32_bf16 v[56:59], v[88:91], v[120:123], v[56:59]
    ds_read_b64_tr_b16 v[110:111], v143 offset:33280
    v_mfma_f32_16x16x32_bf16 v[60:63], v[88:91], v[124:127], v[60:63]
    ds_read_b64_tr_b16 v[112:113], v144 offset:30720
    s_waitcnt lgkmcnt(12)
    v_mfma_f32_16x16x32_bf16 v[64:67], v[92:95], v[116:119], v[64:67]
    ds_read_b64_tr_b16 v[114:115], v144 offset:33280
    v_mfma_f32_16x16x32_bf16 v[68:71], v[92:95], v[120:123], v[68:71]
    v_mfma_f32_16x16x32_bf16 v[72:75], v[92:95], v[124:127], v[72:75]
    s_waitcnt lgkmcnt(10)
    v_mfma_f32_16x16x32_bf16 v[16:19], v[96:99], v[128:131], v[16:19]
    s_waitcnt lgkmcnt(9)
    v_mfma_f32_16x16x32_bf16 v[20:23], v[96:99], v[132:135], v[20:23]
    s_waitcnt lgkmcnt(8)
    v_mfma_f32_16x16x32_bf16 v[24:27], v[96:99], v[136:139], v[24:27]
    s_waitcnt lgkmcnt(6)
    v_mfma_f32_16x16x32_bf16 v[28:31], v[100:103], v[128:131], v[28:31]
    v_mfma_f32_16x16x32_bf16 v[32:35], v[100:103], v[132:135], v[32:35]
    v_mfma_f32_16x16x32_bf16 v[36:39], v[100:103], v[136:139], v[36:39]
    s_waitcnt lgkmcnt(4)
    v_mfma_f32_16x16x32_bf16 v[40:43], v[104:107], v[128:131], v[40:43]
    v_mfma_f32_16x16x32_bf16 v[44:47], v[104:107], v[132:135], v[44:47]
    v_mfma_f32_16x16x32_bf16 v[48:51], v[104:107], v[136:139], v[48:51]
    s_waitcnt lgkmcnt(2)
    v_mfma_f32_16x16x32_bf16 v[52:55], v[108:111], v[128:131], v[52:55]
    v_cvt_pk_bf16_f32 v76, v16, v17
    v_cvt_pk_bf16_f32 v77, v18, v19
    v_mfma_f32_16x16x32_bf16 v[56:59], v[108:111], v[132:135], v[56:59]
    v_cvt_pk_bf16_f32 v78, v28, v29
    v_cvt_pk_bf16_f32 v79, v30, v31
    v_mfma_f32_16x16x32_bf16 v[60:63], v[108:111], v[136:139], v[60:63]
    v_cvt_pk_bf16_f32 v80, v20, v21
    v_cvt_pk_bf16_f32 v81, v22, v23
    s_waitcnt lgkmcnt(0)
    v_mfma_f32_16x16x32_bf16 v[64:67], v[112:115], v[128:131], v[64:67]
    v_cvt_pk_bf16_f32 v82, v32, v33
    v_cvt_pk_bf16_f32 v83, v34, v35
    v_mfma_f32_16x16x32_bf16 v[68:71], v[112:115], v[132:135], v[68:71]
    v_cvt_pk_bf16_f32 v84, v24, v25
    v_cvt_pk_bf16_f32 v85, v26, v27
    v_mfma_f32_16x16x32_bf16 v[72:75], v[112:115], v[136:139], v[72:75]
    v_cvt_pk_bf16_f32 v86, v36, v37
    v_cvt_pk_bf16_f32 v87, v38, v39
    s_lshr_b32 s57, s21, 1
    s_and_b32 s58, s21, 1
    v_cvt_pk_bf16_f32 v96, v40, v41
    v_cvt_pk_bf16_f32 v97, v42, v43
    v_cvt_pk_bf16_f32 v98, v52, v53
    v_cvt_pk_bf16_f32 v99, v54, v55
    v_cvt_pk_bf16_f32 v100, v44, v45
    v_cvt_pk_bf16_f32 v101, v46, v47
    v_cvt_pk_bf16_f32 v102, v56, v57
    v_cvt_pk_bf16_f32 v103, v58, v59
    s_cmp_lg_u32 s57, s20
    s_cbranch_scc1 L_rem0
    s_cmp_lg_u32 s58, 0
    s_cbranch_scc1 L_rem0
    ds_write_b128 v240, v[76:79] offset:0
    ds_write_b128 v240, v[96:99] offset:1024
    ds_write_b128 v240, v[80:83] offset:2048
    ds_write_b128 v240, v[100:103] offset:3072
    s_branch L_remdone0
L_rem0:
    s_add_u32 s56, s67, 0
    buffer_store_dwordx4 v[76:79], v240, s[44:47], s56 offen sc0 sc1
    s_add_u32 s56, s67, 1024
    buffer_store_dwordx4 v[96:99], v240, s[44:47], s56 offen sc0 sc1
    s_add_u32 s56, s67, 2048
    buffer_store_dwordx4 v[80:83], v240, s[44:47], s56 offen sc0 sc1
    s_add_u32 s56, s67, 3072
    buffer_store_dwordx4 v[100:103], v240, s[44:47], s56 offen sc0 sc1
L_remdone0:
    v_cvt_pk_bf16_f32 v104, v48, v49
    v_cvt_pk_bf16_f32 v105, v50, v51
    v_cvt_pk_bf16_f32 v106, v60, v61
    v_cvt_pk_bf16_f32 v107, v62, v63
    v_cvt_pk_bf16_f32 v108, v64, v65
    v_cvt_pk_bf16_f32 v109, v66, v67
    v_cvt_pk_bf16_f32 v110, v68, v69
    v_cvt_pk_bf16_f32 v111, v70, v71
    v_cvt_pk_bf16_f32 v112, v72, v73
    v_cvt_pk_bf16_f32 v113, v74, v75
    s_nop 0
    v_permlane32_swap_b32 v112, v114
    v_permlane32_swap_b32 v113, v115
    s_cmp_lg_u32 s57, s20
    s_cbranch_scc1 L_rem1
    s_cmp_lg_u32 s58, 1
    s_cbranch_scc1 L_rem1
    ds_write_b128 v240, v[84:87] offset:0
    ds_write_b128 v240, v[104:107] offset:1024
    ds_write_b128 v240, v[108:111] offset:2048
    ds_write_b128 v240, v[112:115] offset:3072
    s_branch L_remdone1
L_rem1:
    s_add_u32 s56, s67, 4096
    buffer_store_dwordx4 v[84:87], v240, s[44:47], s56 offen sc0 sc1
    s_add_u32 s56, s67, 5120
    buffer_store_dwordx4 v[104:107], v240, s[44:47], s56 offen sc0 sc1
    s_add_u32 s56, s67, 6144
    buffer_store_dwordx4 v[108:111], v240, s[44:47], s56 offen sc0 sc1
    s_mov_b32 exec_hi, 0
    s_add_u32 s56, s67, 7168
    buffer_store_dwordx4 v[112:115], v240, s[44:47], s56 offen sc0 sc1
    s_mov_b32 exec_hi, -1
L_remdone1:
    s_waitcnt lgkmcnt(0)
    v_mov_b32 v140, 1
    v_mov_b32 v141, 1
    v_mov_b32 v142, 1
    v_mov_b32 v143, 1
    s_waitcnt vmcnt(0)
    s_mov_b64 exec, 0xffff
    buffer_store_dwordx4 v[140:143], v242, s[44:47], 0 offen sc0 sc1
    s_mov_b64 exec, -1
    s_barrier
L_fin:
L_end:
    s_endpgm
.section .rodata,"a"
.p2align 6
.amdhsa_kernel standalone__gqa_block_cached__near_ridge_kernel
  .amdhsa_next_free_vgpr 256
  .amdhsa_next_free_sgpr 102
  .amdhsa_accum_offset 256
  .amdhsa_group_segment_fixed_size 0
  .amdhsa_kernarg_size 64
  .amdhsa_user_sgpr_count 2
  .amdhsa_user_sgpr_kernarg_segment_ptr 1
  .amdhsa_system_sgpr_workgroup_id_x 1
.end_amdhsa_kernel
.text
```
